```python
import torch

def _softmax(x, axis=-1):
    return torch.softmax(x, dim=axis)
def _gelu(x):
    return torch.nn.functional.gelu(x, approximate="tanh")
def _silu(x):
    return torch.nn.functional.silu(x)
def _sigmoid(x):
    return torch.sigmoid(x)
def _layernorm(x, axis=-1, eps=1e-5):
    m = x.mean(dim=axis, keepdim=True)
    v = x.var(dim=axis, keepdim=True, unbiased=False)
    return (x - m) / torch.sqrt(v + eps)
def _scatter_add(tgt, idx, src, axis=0):
    return tgt.clone().index_add_(axis, idx, src)
def _segment_sum(src, seg, n):
    out = torch.zeros((n,) + src.shape[1:], dtype=src.dtype)
    return out.index_add_(0, seg, src)
def _pad(x, pw):
    flat = tuple(v for pair in reversed(pw) for v in pair)
    return torch.nn.functional.pad(x, flat)

kernel_name = 'recurrent_scan__gqa_block_cached__geglu_ffn__decode'

def setup_inputs():

    _w = (lambda a: (lambda t: t.to(torch.bfloat16) if t.is_floating_point() else t)(torch.as_tensor(a)))
    def _A_setup():
        B, Sq, D = 1, 1, 448
        Hq, Hkv, Sk, Dh = 16, 8, 16384, 256
        assert Hq % Hkv == 0, (Hq, Hkv)
        return {
            "x": _w((lambda *s: torch.randn(*s, dtype=torch.bfloat16) * 0.05)(B, Sq, D)),
            "k_cache": _w((lambda *s: torch.randn(*s, dtype=torch.bfloat16) * 0.8)(B, Hkv, Sk, Dh)),
            "v_cache": _w((lambda *s: torch.randn(*s, dtype=torch.bfloat16) * 0.8)(B, Hkv, Sk, Dh)),
            "wq": _w((lambda *s: torch.randn(*s, dtype=torch.bfloat16) * 0.8)(D, Hq * Dh) * (D ** -0.5)),
            "wo": _w((lambda *s: torch.randn(*s, dtype=torch.bfloat16) * 0.8)(Hq * Dh, D) * ((Hq * Dh) ** -0.5)),
        }
    _A_in = _A_setup()

    def _B_setup():
        B, S, D, F = 1, 1, 448, 1792
        return {
            "x": _w((lambda *s: torch.randn(*s, dtype=torch.bfloat16) * 0.05)(B, S, D)),
            "w_gate": _w((lambda *s: torch.randn(*s, dtype=torch.bfloat16) * 0.2)(D, F)),
            "w_up": _w((lambda *s: torch.randn(*s, dtype=torch.bfloat16) * 0.2)(D, F)),
            "w_down": _w((lambda *s: torch.randn(*s, dtype=torch.bfloat16) * 0.2)(F, D)),
        }
    _B_in = _B_setup()

    return {
        "A_x": _A_in["x"],
        "A_k_cache": _A_in["k_cache"],
        "A_v_cache": _A_in["v_cache"],
        "A_wq": _A_in["wq"],
        "A_wo": _A_in["wo"],
        "B_x": _B_in["x"],
        "B_w_gate": _B_in["w_gate"],
        "B_w_up": _B_in["w_up"],
        "B_w_down": _B_in["w_down"],
    }

def reference(A_x, A_k_cache, A_v_cache, A_wq, A_wo, B_x, B_w_gate, B_w_up, B_w_down):
    def _A_ref(x, k_cache, v_cache, wq, wo):
        B, Sq, D = x.shape
        Hq, Dh = 16, 256
        Hkv = k_cache.shape[1]
        rep = Hq // Hkv
        q = (lambda x, *d: x.permute(*d))((x @ wq).reshape(B, Sq, Hq, Dh), 0, 2, 1, 3)
        k = (lambda x, n, axis: torch.repeat_interleave(x, n, dim=axis))(k_cache, rep, axis=1)
        v = (lambda x, n, axis: torch.repeat_interleave(x, n, dim=axis))(v_cache, rep, axis=1)
        scores = torch.einsum("bhqd,bhkd->bhqk", q, k) * (Dh ** -0.5)
        p = _softmax(scores, axis=-1)
        o = torch.einsum("bhqk,bhkd->bhqd", p, v)
        return (lambda x, *d: x.permute(*d))(o, 0, 2, 1, 3).reshape(B, Sq, Hq * Dh) @ wo

    def _B_ref(x, w_gate, w_up, w_down):
        return (_gelu(x @ w_gate) * (x @ w_up)) @ w_down

    x = A_x
    xn = _layernorm(x, axis=-1)
    s = _A_ref(xn, A_k_cache, A_v_cache, A_wq, A_wo)
    g = _silu(_B_ref(xn, B_w_gate, B_w_up, B_w_down))
    return x + s * g
```

```asm
; @launch grid=(256,1,1) block=(384,1,1) lds=148864
.amdgcn_target "amdgcn-amd-amdhsa--gfx950"
.text
.globl recurrent_scan__gqa_block_cached__geglu_ffn__decode_kernel
.p2align 8
.type recurrent_scan__gqa_block_cached__geglu_ffn__decode_kernel,@function
recurrent_scan__gqa_block_cached__geglu_ffn__decode_kernel:
    s_cmp_ge_u32 s2, 256
    s_cbranch_scc1 L_end
    s_load_dwordx16 s[4:19], s[0:1], 0
    s_load_dwordx4 s[20:23], s[0:1], 64
    s_load_dwordx2 s[24:25], s[0:1], 88
    v_lshrrev_b32 v2, 6, v0
    v_and_b32 v1, 63, v0
    v_readfirstlane_b32 s27, v2
    v_lshlrev_b32 v2, 2, v1
    v_add_u32 v2, 140288, v2
    v_mov_b32 v3, 0
    ds_write_b32 v2, v3
    s_and_b32 s28, s2, 7
    s_lshr_b32 s29, s2, 3
    v_and_b32 v18, 15, v1
    v_lshrrev_b32 v19, 4, v1
    v_lshlrev_b32 v10, 4, v1
    v_lshrrev_b32 v148, 5, v1
    v_and_b32 v149, 31, v1
    v_lshlrev_b32 v150, 9, v148
    v_add_u32 v151, 0, v148
    v_xor_b32 v151, v151, v149
    v_lshl_add_u32 v2, v151, 4, v150
    v_add_u32 v151, 2, v148
    v_xor_b32 v151, v151, v149
    v_lshl_add_u32 v3, v151, 4, v150
    v_add_u32 v151, 4, v148
    v_xor_b32 v151, v151, v149
    v_lshl_add_u32 v4, v151, 4, v150
    v_add_u32 v151, 6, v148
    v_xor_b32 v151, v151, v149
    v_lshl_add_u32 v5, v151, 4, v150
    v_add_u32 v151, 8, v148
    v_xor_b32 v151, v151, v149
    v_lshl_add_u32 v6, v151, 4, v150
    v_add_u32 v151, 10, v148
    v_xor_b32 v151, v151, v149
    v_lshl_add_u32 v7, v151, 4, v150
    v_add_u32 v151, 12, v148
    v_xor_b32 v151, v151, v149
    v_lshl_add_u32 v8, v151, 4, v150
    v_add_u32 v151, 14, v148
    v_xor_b32 v151, v151, v149
    v_lshl_add_u32 v9, v151, 4, v150
    v_lshrrev_b32 v152, 3, v18
    v_lshl_add_u32 v152, v19, 1, v152
    v_lshlrev_b32 v152, 13, v152
    v_and_b32 v153, 7, v18
    v_lshl_add_u32 v152, v153, 4, v152
    s_waitcnt lgkmcnt(0)
    s_load_dwordx2 s[30:31], s[24:25], 0
    s_cmp_lg_u32 s27, 4
    s_cbranch_scc1 L_nohq_1
    s_mov_b32 s32, s4
    s_and_b32 s33, s5, 0xffff
    s_mov_b32 s34, 896
    s_mov_b32 s35, 0x20000
    s_mov_b32 s36, s10
    s_and_b32 s37, s11, 0xffff
    s_mov_b32 s38, 3670016
    s_mov_b32 s39, 0x20000
    buffer_load_dwordx4 v[204:207], v10, s[32:35], 0 offen
    s_and_b32 s65, s29, 3
    s_lshr_b32 s66, s29, 2
    s_mul_i32 s55, s65, 917504
    s_lshl_b32 s56, s28, 10
    s_add_u32 s55, s55, s56
    s_lshl_b32 s56, s66, 7
    s_add_u32 s55, s55, s56
    buffer_load_dwordx4 v[64:67], v152, s[36:39], s55 offen nt
    s_add_u32 s55, s55, 65536
    buffer_load_dwordx4 v[68:71], v152, s[36:39], s55 offen nt
    s_add_u32 s55, s55, 65536
    buffer_load_dwordx4 v[72:75], v152, s[36:39], s55 offen nt
    s_add_u32 s55, s55, 65536
    buffer_load_dwordx4 v[76:79], v152, s[36:39], s55 offen nt
    s_add_u32 s55, s55, 65536
    buffer_load_dwordx4 v[80:83], v152, s[36:39], s55 offen nt
    s_add_u32 s55, s55, 65536
    buffer_load_dwordx4 v[84:87], v152, s[36:39], s55 offen nt
    s_add_u32 s55, s55, 65536
    buffer_load_dwordx4 v[88:91], v152, s[36:39], s55 offen nt
    s_add_u32 s55, s55, 65536
    buffer_load_dwordx4 v[92:95], v152, s[36:39], s55 offen nt
    s_add_u32 s55, s55, 65536
    buffer_load_dwordx4 v[96:99], v152, s[36:39], s55 offen nt
    s_add_u32 s55, s55, 65536
    buffer_load_dwordx4 v[100:103], v152, s[36:39], s55 offen nt
    s_add_u32 s55, s55, 65536
    buffer_load_dwordx4 v[104:107], v152, s[36:39], s55 offen nt
    s_add_u32 s55, s55, 65536
    buffer_load_dwordx4 v[108:111], v152, s[36:39], s55 offen nt
    s_add_u32 s55, s55, 65536
    buffer_load_dwordx4 v[112:115], v152, s[36:39], s55 offen nt
    s_add_u32 s55, s55, 65536
    buffer_load_dwordx4 v[116:119], v152, s[36:39], s55 offen nt
L_nohq_1:
    s_cmp_ge_u32 s27, 4
    s_cbranch_scc1 L_noearly_2
    s_mov_b32 s32, s6
    s_and_b32 s33, s7, 0xffff
    s_mov_b32 s34, 67108864
    s_mov_b32 s35, 0x20000
    s_lshl_b32 s55, s28, 23
    s_lshl_b32 s56, s29, 18
    s_add_u32 s55, s55, s56
    s_lshl_b32 s56, s27, 13
    s_add_u32 s55, s55, s56
    s_lshl_b32 s56, s27, 15
    s_add_u32 s57, s55, 0
    s_mov_b32 m0, s56
    s_nop 0
    buffer_load_dwordx4 v2, s[32:35], s57 offen offset:0 nt lds
    buffer_load_dwordx4 v3, s[32:35], s57 offen offset:1024 nt lds
    buffer_load_dwordx4 v4, s[32:35], s57 offen offset:2048 nt lds
    buffer_load_dwordx4 v5, s[32:35], s57 offen offset:3072 nt lds
L_noearly_2:
    s_mov_b32 s44, s24
    s_and_b32 s45, s25, 0xffff
    s_mov_b32 s46, 2818048
    s_mov_b32 s47, 0x20000
    s_barrier
    s_cmp_ge_u32 s27, 4
    s_cbranch_scc1 L_help
    s_mov_b32 s32, s6
    s_and_b32 s33, s7, 0xffff
    s_mov_b32 s34, 67108864
    s_mov_b32 s35, 0x20000
    s_add_u32 s57, s57, 4096
    s_add_u32 m0, s56, 4096
    s_nop 0
    buffer_load_dwordx4 v6, s[32:35], s57 offen offset:0 nt lds
    buffer_load_dwordx4 v7, s[32:35], s57 offen offset:1024 nt lds
    s_waitcnt vmcnt(5)
    buffer_load_dwordx4 v8, s[32:35], s57 offen offset:2048 nt lds
    s_waitcnt vmcnt(5)
    buffer_load_dwordx4 v9, s[32:35], s57 offen offset:3072 nt lds
    s_mov_b32 s36, s8
    s_and_b32 s37, s9, 0xffff
    s_mov_b32 s38, 67108864
    s_mov_b32 s39, 0x20000
    s_mov_b32 s40, s12
    s_and_b32 s41, s13, 0xffff
    s_mov_b32 s42, 3670016
    s_mov_b32 s43, 0x20000
    s_add_u32 s57, s55, 32768
    s_add_u32 m0, s56, 8192
    s_waitcnt vmcnt(5)
    buffer_load_dwordx4 v2, s[32:35], s57 offen offset:0 nt lds
    s_waitcnt vmcnt(5)
    buffer_load_dwordx4 v3, s[32:35], s57 offen offset:1024 nt lds
    s_waitcnt vmcnt(5)
    buffer_load_dwordx4 v4, s[32:35], s57 offen offset:2048 nt lds
    s_waitcnt vmcnt(5)
    buffer_load_dwordx4 v5, s[32:35], s57 offen offset:3072 nt lds
    s_add_u32 s57, s57, 4096
    s_add_u32 m0, s56, 12288
    s_waitcnt vmcnt(5)
    buffer_load_dwordx4 v6, s[32:35], s57 offen offset:0 nt lds
    s_waitcnt vmcnt(5)
    buffer_load_dwordx4 v7, s[32:35], s57 offen offset:1024 nt lds
    s_waitcnt vmcnt(5)
    buffer_load_dwordx4 v8, s[32:35], s57 offen offset:2048 nt lds
    s_waitcnt vmcnt(5)
    buffer_load_dwordx4 v9, s[32:35], s57 offen offset:3072 nt lds
    v_lshrrev_b32 v148, 2, v18
    v_and_b32 v149, 3, v18
    v_xor_b32 v149, v149, v19
    v_lshlrev_b32 v150, 9, v18
    v_add_u32 v150, s56, v150
    v_xor_b32 v151, 0, v148
    v_lshl_add_u32 v151, v151, 2, v149
    v_lshl_add_u32 v11, v151, 4, v150
    v_xor_b32 v151, 1, v148
    v_lshl_add_u32 v151, v151, 2, v149
    v_lshl_add_u32 v12, v151, 4, v150
    v_xor_b32 v151, 2, v148
    v_lshl_add_u32 v151, v151, 2, v149
    v_lshl_add_u32 v13, v151, 4, v150
    v_xor_b32 v151, 3, v148
    v_lshl_add_u32 v151, v151, 2, v149
    v_lshl_add_u32 v14, v151, 4, v150
    v_lshlrev_b32 v15, 11, v19
    v_lshl_add_u32 v15, v18, 4, v15
    v_add_u32 v15, s56, v15
    s_lshl_b32 s59, s27, 10
    s_add_u32 s59, s59, 136192
    v_bfe_u32 v148, v1, 3, 1
    v_lshlrev_b32 v148, 9, v148
    v_lshl_add_u32 v16, v19, 4, v148
    v_add_u32 v16, s59, v16
    v_and_b32 v148, 1, v19
    v_lshlrev_b32 v148, 9, v148
    v_lshrrev_b32 v149, 1, v19
    v_lshl_add_u32 v148, v149, 6, v148
    v_lshl_add_u32 v17, v18, 2, v148
    v_add_u32 v17, s59, v17
    v_and_b32 v148, 1, v1
    v_mov_b32 v149, 0xffff
    v_cmp_eq_u32 vcc, 1, v148
    v_mov_b32 v148, 0xffff0000
    s_nop 0
    v_cndmask_b32 v149, v149, v148, vcc
    v_bfe_u32 v148, v1, 1, 2
    v_cmp_eq_u32 vcc, 0, v148
    s_nop 1
    v_cndmask_b32 v20, 0, v149, vcc
    v_cmp_eq_u32 vcc, 1, v148
    s_nop 1
    v_cndmask_b32 v21, 0, v149, vcc
    v_cmp_eq_u32 vcc, 2, v148
    s_nop 1
    v_cndmask_b32 v22, 0, v149, vcc
    v_cmp_eq_u32 vcc, 3, v148
    s_nop 1
    v_cndmask_b32 v23, 0, v149, vcc
    v_mov_b32 v40, 0
    v_mov_b32 v44, 0
    v_mov_b32 v41, 0
    v_mov_b32 v45, 0
    v_mov_b32 v42, 0
    v_mov_b32 v46, 0
    v_mov_b32 v43, 0
    v_mov_b32 v47, 0
    s_add_u32 s57, s55, 65536
    s_add_u32 m0, s56, 16384
    s_waitcnt vmcnt(5)
    buffer_load_dwordx4 v2, s[32:35], s57 offen offset:0 nt lds
    s_waitcnt vmcnt(5)
    buffer_load_dwordx4 v3, s[32:35], s57 offen offset:1024 nt lds
    s_waitcnt vmcnt(5)
    buffer_load_dwordx4 v4, s[32:35], s57 offen offset:2048 nt lds
    s_waitcnt vmcnt(5)
    buffer_load_dwordx4 v5, s[32:35], s57 offen offset:3072 nt lds
    s_add_u32 s57, s57, 4096
    s_add_u32 m0, s56, 20480
    s_waitcnt vmcnt(5)
    buffer_load_dwordx4 v6, s[32:35], s57 offen offset:0 nt lds
    s_waitcnt vmcnt(5)
    buffer_load_dwordx4 v7, s[32:35], s57 offen offset:1024 nt lds
    s_waitcnt vmcnt(5)
    buffer_load_dwordx4 v8, s[32:35], s57 offen offset:2048 nt lds
    s_waitcnt vmcnt(5)
    buffer_load_dwordx4 v9, s[32:35], s57 offen offset:3072 nt lds
    s_add_u32 s57, s55, 98304
    s_add_u32 m0, s56, 24576
    s_waitcnt vmcnt(5)
    buffer_load_dwordx4 v2, s[32:35], s57 offen offset:0 nt lds
    s_waitcnt vmcnt(5)
    buffer_load_dwordx4 v3, s[32:35], s57 offen offset:1024 nt lds
    s_waitcnt vmcnt(5)
    buffer_load_dwordx4 v4, s[32:35], s57 offen offset:2048 nt lds
    s_waitcnt vmcnt(5)
    buffer_load_dwordx4 v5, s[32:35], s57 offen offset:3072 nt lds
    s_add_u32 s57, s57, 4096
    s_add_u32 m0, s56, 28672
    s_waitcnt vmcnt(5)
    buffer_load_dwordx4 v6, s[32:35], s57 offen offset:0 nt lds
    s_waitcnt vmcnt(5)
    buffer_load_dwordx4 v7, s[32:35], s57 offen offset:1024 nt lds
    s_waitcnt vmcnt(5)
    buffer_load_dwordx4 v8, s[32:35], s57 offen offset:2048 nt lds
    s_waitcnt vmcnt(5)
    buffer_load_dwordx4 v9, s[32:35], s57 offen offset:3072 nt lds
    s_waitcnt lgkmcnt(0)
    s_mov_b32 s52, 0x3ff
    s_add_u32 s26, s30, 1
    s_and_b32 s26, s26, 0x3ff
    s_bfe_u32 s53, s30, 0xa000a
    s_add_u32 s53, s53, 1
    s_and_b32 s53, s53, 0x3ff
    v_mov_b32 v24, s26
    v_mov_b32 v25, s53
    s_lshl_b32 s53, s53, 10
    s_or_b32 s30, s26, s53
    s_add_u32 s26, s31, 1
    s_and_b32 s26, s26, 0x3ff
    s_bfe_u32 s53, s31, 0xa000a
    s_add_u32 s53, s53, 1
    s_and_b32 s53, s53, 0x3ff
    v_mov_b32 v26, s26
    v_mov_b32 v27, s53
    s_lshl_b32 s53, s53, 10
    s_or_b32 s31, s26, s53
    v_mov_b32 v148, 140512
    s_mov_b32 s64, 1600000
L_lw_3:
    ds_read_b32 v149, v148
    s_waitcnt lgkmcnt(0)
    v_readfirstlane_b32 s65, v149
    s_nop 0
    s_cmp_eq_u32 s65, 1
    s_cbranch_scc1 L_lwd_4
    s_sub_u32 s64, s64, 1
    s_cmp_eq_u32 s64, 0
    s_cbranch_scc1 L_lwd_4
    s_sleep 1
    s_branch L_lw_3
L_lwd_4:
    v_bfe_u32 v148, v1, 2, 1
    v_lshlrev_b32 v148, 9, v148
    v_lshl_add_u32 v148, v19, 4, v148
    v_add_u32 v148, 131072, v148
    ds_read_b128 v[68:71], v148 offset:0
    ds_read_b128 v[72:75], v148 offset:64
    ds_read_b128 v[76:79], v148 offset:128
    ds_read_b128 v[80:83], v148 offset:192
    ds_read_b128 v[84:87], v148 offset:256
    ds_read_b128 v[88:91], v148 offset:320
    ds_read_b128 v[92:95], v148 offset:384
    ds_read_b128 v[96:99], v148 offset:448
    s_mov_b32 s60, 0
    s_mov_b32 s61, -1
    s_waitcnt lgkmcnt(0)
    ds_read_b128 v[100:103], v11 offset:0
    ds_read_b128 v[104:107], v12 offset:0
    ds_read_b128 v[108:111], v13 offset:0
    ds_read_b128 v[112:115], v14 offset:0
    ds_read_b128 v[116:119], v11 offset:256
    ds_read_b128 v[120:123], v12 offset:256
    ds_read_b128 v[124:127], v13 offset:256
    ds_read_b128 v[128:131], v14 offset:256
    s_waitcnt lgkmcnt(4)
    v_mfma_f32_16x16x32_bf16 v[32:35], v[68:71], v[100:103], 0
    v_mfma_f32_16x16x32_bf16 v[32:35], v[72:75], v[104:107], v[32:35]
    v_mfma_f32_16x16x32_bf16 v[32:35], v[76:79], v[108:111], v[32:35]
    v_mfma_f32_16x16x32_bf16 v[32:35], v[80:83], v[112:115], v[32:35]
    s_waitcnt lgkmcnt(0)
    v_mfma_f32_16x16x32_bf16 v[32:35], v[84:87], v[116:119], v[32:35]
    v_mfma_f32_16x16x32_bf16 v[32:35], v[88:91], v[120:123], v[32:35]
    v_mfma_f32_16x16x32_bf16 v[32:35], v[92:95], v[124:127], v[32:35]
    v_mfma_f32_16x16x32_bf16 v[32:35], v[96:99], v[128:131], v[32:35]
    s_add_u32 s57, s55, 131072
    s_add_u32 m0, s56, 0
    s_waitcnt vmcnt(4)
    buffer_load_dwordx4 v2, s[32:35], s57 offen offset:0 nt lds
    s_waitcnt vmcnt(4)
    buffer_load_dwordx4 v3, s[32:35], s57 offen offset:1024 nt lds
    ds_read_b128 v[100:103], v11 offset:8192
    ds_read_b128 v[104:107], v12 offset:8192
    ds_read_b128 v[108:111], v13 offset:8192
    ds_read_b128 v[112:115], v14 offset:8192
    ds_read_b128 v[116:119], v11 offset:8448
    ds_read_b128 v[120:123], v12 offset:8448
    ds_read_b128 v[124:127], v13 offset:8448
    ds_read_b128 v[128:131], v14 offset:8448
    s_waitcnt vmcnt(4)
    buffer_load_dwordx4 v4, s[32:35], s57 offen offset:2048 nt lds
    s_waitcnt vmcnt(4)
    buffer_load_dwordx4 v5, s[32:35], s57 offen offset:3072 nt lds
    s_waitcnt lgkmcnt(4)
    v_mfma_f32_16x16x32_bf16 v[36:39], v[68:71], v[100:103], 0
    v_mfma_f32_16x16x32_bf16 v[36:39], v[72:75], v[104:107], v[36:39]
    v_mfma_f32_16x16x32_bf16 v[36:39], v[76:79], v[108:111], v[36:39]
    v_mfma_f32_16x16x32_bf16 v[36:39], v[80:83], v[112:115], v[36:39]
    s_add_u32 s57, s57, 4096
    s_add_u32 m0, s56, 4096
    s_waitcnt vmcnt(4)
    buffer_load_dwordx4 v6, s[32:35], s57 offen offset:0 nt lds
    s_waitcnt vmcnt(4)
    buffer_load_dwordx4 v7, s[32:35], s57 offen offset:1024 nt lds
    s_waitcnt lgkmcnt(0)
    v_mfma_f32_16x16x32_bf16 v[36:39], v[84:87], v[116:119], v[36:39]
    v_mfma_f32_16x16x32_bf16 v[36:39], v[88:91], v[120:123], v[36:39]
    v_mfma_f32_16x16x32_bf16 v[36:39], v[92:95], v[124:127], v[36:39]
    v_mfma_f32_16x16x32_bf16 v[36:39], v[96:99], v[128:131], v[36:39]
    s_waitcnt vmcnt(4)
    buffer_load_dwordx4 v8, s[32:35], s57 offen offset:2048 nt lds
    s_waitcnt vmcnt(4)
    buffer_load_dwordx4 v9, s[32:35], s57 offen offset:3072 nt lds
    s_nop 3
    v_cndmask_b32 v28, v32, v36, s[60:61]
    s_add_u32 s57, s55, 163840
    s_add_u32 m0, s56, 8192
    s_waitcnt vmcnt(4)
    buffer_load_dwordx4 v2, s[32:35], s57 offen offset:0 nt lds
    s_waitcnt vmcnt(4)
    buffer_load_dwordx4 v3, s[32:35], s57 offen offset:1024 nt lds
    ds_read_b128 v[100:103], v11 offset:16384
    ds_read_b128 v[104:107], v12 offset:16384
    ds_read_b128 v[108:111], v13 offset:16384
    ds_read_b128 v[112:115], v14 offset:16384
    ds_read_b128 v[116:119], v11 offset:16640
    ds_read_b128 v[120:123], v12 offset:16640
    ds_read_b128 v[124:127], v13 offset:16640
    ds_read_b128 v[128:131], v14 offset:16640
    s_waitcnt vmcnt(4)
    buffer_load_dwordx4 v4, s[32:35], s57 offen offset:2048 nt lds
    s_waitcnt vmcnt(4)
    buffer_load_dwordx4 v5, s[32:35], s57 offen offset:3072 nt lds
    s_waitcnt lgkmcnt(4)
    v_mfma_f32_16x16x32_bf16 v[32:35], v[68:71], v[100:103], 0
    v_mfma_f32_16x16x32_bf16 v[32:35], v[72:75], v[104:107], v[32:35]
    v_mfma_f32_16x16x32_bf16 v[32:35], v[76:79], v[108:111], v[32:35]
    v_mfma_f32_16x16x32_bf16 v[32:35], v[80:83], v[112:115], v[32:35]
    s_add_u32 s57, s57, 4096
    s_add_u32 m0, s56, 12288
    s_waitcnt vmcnt(4)
    buffer_load_dwordx4 v6, s[32:35], s57 offen offset:0 nt lds
    s_waitcnt vmcnt(4)
    buffer_load_dwordx4 v7, s[32:35], s57 offen offset:1024 nt lds
    s_waitcnt lgkmcnt(0)
    v_mfma_f32_16x16x32_bf16 v[32:35], v[84:87], v[116:119], v[32:35]
    v_mfma_f32_16x16x32_bf16 v[32:35], v[88:91], v[120:123], v[32:35]
    v_mfma_f32_16x16x32_bf16 v[32:35], v[92:95], v[124:127], v[32:35]
    v_mfma_f32_16x16x32_bf16 v[32:35], v[96:99], v[128:131], v[32:35]
    s_waitcnt vmcnt(4)
    buffer_load_dwordx4 v8, s[32:35], s57 offen offset:2048 nt lds
    s_waitcnt vmcnt(4)
    buffer_load_dwordx4 v9, s[32:35], s57 offen offset:3072 nt lds
    s_add_u32 s57, s55, 196608
    s_add_u32 m0, s56, 16384
    s_waitcnt vmcnt(4)
    buffer_load_dwordx4 v2, s[32:35], s57 offen offset:0 nt lds
    s_waitcnt vmcnt(4)
    buffer_load_dwordx4 v3, s[32:35], s57 offen offset:1024 nt lds
    ds_read_b128 v[100:103], v11 offset:24576
    ds_read_b128 v[104:107], v12 offset:24576
    ds_read_b128 v[108:111], v13 offset:24576
    ds_read_b128 v[112:115], v14 offset:24576
    ds_read_b128 v[116:119], v11 offset:24832
    ds_read_b128 v[120:123], v12 offset:24832
    ds_read_b128 v[124:127], v13 offset:24832
    ds_read_b128 v[128:131], v14 offset:24832
    s_waitcnt vmcnt(4)
    buffer_load_dwordx4 v4, s[32:35], s57 offen offset:2048 nt lds
    s_waitcnt vmcnt(4)
    buffer_load_dwordx4 v5, s[32:35], s57 offen offset:3072 nt lds
    s_waitcnt lgkmcnt(4)
    v_mfma_f32_16x16x32_bf16 v[36:39], v[68:71], v[100:103], 0
    v_mfma_f32_16x16x32_bf16 v[36:39], v[72:75], v[104:107], v[36:39]
    v_mfma_f32_16x16x32_bf16 v[36:39], v[76:79], v[108:111], v[36:39]
    v_mfma_f32_16x16x32_bf16 v[36:39], v[80:83], v[112:115], v[36:39]
    s_add_u32 s57, s57, 4096
    s_add_u32 m0, s56, 20480
    s_waitcnt vmcnt(4)
    buffer_load_dwordx4 v6, s[32:35], s57 offen offset:0 nt lds
    s_waitcnt vmcnt(4)
    buffer_load_dwordx4 v7, s[32:35], s57 offen offset:1024 nt lds
    s_waitcnt lgkmcnt(0)
    v_mfma_f32_16x16x32_bf16 v[36:39], v[84:87], v[116:119], v[36:39]
    v_mfma_f32_16x16x32_bf16 v[36:39], v[88:91], v[120:123], v[36:39]
    v_mfma_f32_16x16x32_bf16 v[36:39], v[92:95], v[124:127], v[36:39]
    v_mfma_f32_16x16x32_bf16 v[36:39], v[96:99], v[128:131], v[36:39]
    s_waitcnt vmcnt(4)
    buffer_load_dwordx4 v8, s[32:35], s57 offen offset:2048 nt lds
    s_waitcnt vmcnt(4)
    buffer_load_dwordx4 v9, s[32:35], s57 offen offset:3072 nt lds
    s_nop 3
    v_cndmask_b32 v29, v32, v36, s[60:61]
    s_add_u32 s57, s55, 229376
    s_add_u32 m0, s56, 24576
    s_waitcnt vmcnt(4)
    buffer_load_dwordx4 v2, s[32:35], s57 offen offset:0 nt lds
    s_waitcnt vmcnt(4)
    buffer_load_dwordx4 v3, s[32:35], s57 offen offset:1024 nt lds
    ds_read_b128 v[100:103], v11 offset:0
    ds_read_b128 v[104:107], v12 offset:0
    ds_read_b128 v[108:111], v13 offset:0
    ds_read_b128 v[112:115], v14 offset:0
    ds_read_b128 v[116:119], v11 offset:256
    ds_read_b128 v[120:123], v12 offset:256
    ds_read_b128 v[124:127], v13 offset:256
    ds_read_b128 v[128:131], v14 offset:256
    s_waitcnt vmcnt(4)
    buffer_load_dwordx4 v4, s[32:35], s57 offen offset:2048 nt lds
    s_waitcnt vmcnt(4)
    buffer_load_dwordx4 v5, s[32:35], s57 offen offset:3072 nt lds
    s_waitcnt lgkmcnt(4)
    v_mfma_f32_16x16x32_bf16 v[32:35], v[68:71], v[100:103], 0
    v_mfma_f32_16x16x32_bf16 v[32:35], v[72:75], v[104:107], v[32:35]
    v_mfma_f32_16x16x32_bf16 v[32:35], v[76:79], v[108:111], v[32:35]
    v_mfma_f32_16x16x32_bf16 v[32:35], v[80:83], v[112:115], v[32:35]
    s_add_u32 s57, s57, 4096
    s_add_u32 m0, s56, 28672
    s_waitcnt vmcnt(4)
    buffer_load_dwordx4 v6, s[32:35], s57 offen offset:0 nt lds
    s_waitcnt vmcnt(4)
    buffer_load_dwordx4 v7, s[32:35], s57 offen offset:1024 nt lds
    s_waitcnt lgkmcnt(0)
    v_mfma_f32_16x16x32_bf16 v[32:35], v[84:87], v[116:119], v[32:35]
    v_mfma_f32_16x16x32_bf16 v[32:35], v[88:91], v[120:123], v[32:35]
    v_mfma_f32_16x16x32_bf16 v[32:35], v[92:95], v[124:127], v[32:35]
    v_mfma_f32_16x16x32_bf16 v[32:35], v[96:99], v[128:131], v[32:35]
    s_waitcnt vmcnt(4)
    buffer_load_dwordx4 v8, s[32:35], s57 offen offset:2048 nt lds
    s_waitcnt vmcnt(4)
    buffer_load_dwordx4 v9, s[32:35], s57 offen offset:3072 nt lds
    s_add_u32 s57, s55, 0
    s_add_u32 m0, s56, 0
    s_waitcnt vmcnt(4)
    buffer_load_dwordx4 v10, s[36:39], s57 offen offset:0 nt lds
    s_waitcnt vmcnt(4)
    buffer_load_dwordx4 v10, s[36:39], s57 offen offset:1024 nt lds
    ds_read_b128 v[100:103], v11 offset:8192
    ds_read_b128 v[104:107], v12 offset:8192
    ds_read_b128 v[108:111], v13 offset:8192
    ds_read_b128 v[112:115], v14 offset:8192
    ds_read_b128 v[116:119], v11 offset:8448
    ds_read_b128 v[120:123], v12 offset:8448
    ds_read_b128 v[124:127], v13 offset:8448
    ds_read_b128 v[128:131], v14 offset:8448
    s_waitcnt vmcnt(4)
    buffer_load_dwordx4 v10, s[36:39], s57 offen offset:2048 nt lds
    s_waitcnt vmcnt(4)
    buffer_load_dwordx4 v10, s[36:39], s57 offen offset:3072 nt lds
    s_waitcnt lgkmcnt(4)
    v_mfma_f32_16x16x32_bf16 v[36:39], v[68:71], v[100:103], 0
    v_mfma_f32_16x16x32_bf16 v[36:39], v[72:75], v[104:107], v[36:39]
    v_mfma_f32_16x16x32_bf16 v[36:39], v[76:79], v[108:111], v[36:39]
    v_mfma_f32_16x16x32_bf16 v[36:39], v[80:83], v[112:115], v[36:39]
    s_add_u32 s57, s57, 4096
    s_add_u32 m0, s56, 4096
    s_waitcnt vmcnt(4)
    buffer_load_dwordx4 v10, s[36:39], s57 offen offset:0 nt lds
    s_waitcnt vmcnt(4)
    buffer_load_dwordx4 v10, s[36:39], s57 offen offset:1024 nt lds
    s_waitcnt lgkmcnt(0)
    v_mfma_f32_16x16x32_bf16 v[36:39], v[84:87], v[116:119], v[36:39]
    v_mfma_f32_16x16x32_bf16 v[36:39], v[88:91], v[120:123], v[36:39]
    v_mfma_f32_16x16x32_bf16 v[36:39], v[92:95], v[124:127], v[36:39]
    v_mfma_f32_16x16x32_bf16 v[36:39], v[96:99], v[128:131], v[36:39]
    s_waitcnt vmcnt(4)
    buffer_load_dwordx4 v10, s[36:39], s57 offen offset:2048 nt lds
    s_waitcnt vmcnt(4)
    buffer_load_dwordx4 v10, s[36:39], s57 offen offset:3072 nt lds
    s_nop 3
    v_cndmask_b32 v30, v32, v36, s[60:61]
    s_add_u32 s57, s55, 32768
    s_add_u32 m0, s56, 8192
    s_waitcnt vmcnt(4)
    buffer_load_dwordx4 v10, s[36:39], s57 offen offset:0 nt lds
    s_waitcnt vmcnt(4)
    buffer_load_dwordx4 v10, s[36:39], s57 offen offset:1024 nt lds
    ds_read_b128 v[100:103], v11 offset:16384
    ds_read_b128 v[104:107], v12 offset:16384
    ds_read_b128 v[108:111], v13 offset:16384
    ds_read_b128 v[112:115], v14 offset:16384
    ds_read_b128 v[116:119], v11 offset:16640
    ds_read_b128 v[120:123], v12 offset:16640
    ds_read_b128 v[124:127], v13 offset:16640
    ds_read_b128 v[128:131], v14 offset:16640
    s_waitcnt vmcnt(4)
    buffer_load_dwordx4 v10, s[36:39], s57 offen offset:2048 nt lds
    s_waitcnt vmcnt(4)
    buffer_load_dwordx4 v10, s[36:39], s57 offen offset:3072 nt lds
    s_waitcnt lgkmcnt(4)
    v_mfma_f32_16x16x32_bf16 v[32:35], v[68:71], v[100:103], 0
    v_mfma_f32_16x16x32_bf16 v[32:35], v[72:75], v[104:107], v[32:35]
    v_mfma_f32_16x16x32_bf16 v[32:35], v[76:79], v[108:111], v[32:35]
    v_mfma_f32_16x16x32_bf16 v[32:35], v[80:83], v[112:115], v[32:35]
    s_add_u32 s57, s57, 4096
    s_add_u32 m0, s56, 12288
    s_waitcnt vmcnt(4)
    buffer_load_dwordx4 v10, s[36:39], s57 offen offset:0 nt lds
    s_waitcnt vmcnt(4)
    buffer_load_dwordx4 v10, s[36:39], s57 offen offset:1024 nt lds
    s_waitcnt lgkmcnt(0)
    v_mfma_f32_16x16x32_bf16 v[32:35], v[84:87], v[116:119], v[32:35]
    v_mfma_f32_16x16x32_bf16 v[32:35], v[88:91], v[120:123], v[32:35]
    v_mfma_f32_16x16x32_bf16 v[32:35], v[92:95], v[124:127], v[32:35]
    v_mfma_f32_16x16x32_bf16 v[32:35], v[96:99], v[128:131], v[32:35]
    s_waitcnt vmcnt(4)
    buffer_load_dwordx4 v10, s[36:39], s57 offen offset:2048 nt lds
    s_waitcnt vmcnt(4)
    buffer_load_dwordx4 v10, s[36:39], s57 offen offset:3072 nt lds
    s_add_u32 s57, s55, 65536
    s_add_u32 m0, s56, 16384
    s_waitcnt vmcnt(4)
    buffer_load_dwordx4 v10, s[36:39], s57 offen offset:0 nt lds
    s_waitcnt vmcnt(4)
    buffer_load_dwordx4 v10, s[36:39], s57 offen offset:1024 nt lds
    ds_read_b128 v[100:103], v11 offset:24576
    ds_read_b128 v[104:107], v12 offset:24576
    ds_read_b128 v[108:111], v13 offset:24576
    ds_read_b128 v[112:115], v14 offset:24576
    ds_read_b128 v[116:119], v11 offset:24832
    ds_read_b128 v[120:123], v12 offset:24832
    ds_read_b128 v[124:127], v13 offset:24832
    ds_read_b128 v[128:131], v14 offset:24832
    s_waitcnt vmcnt(4)
    buffer_load_dwordx4 v10, s[36:39], s57 offen offset:2048 nt lds
    s_waitcnt vmcnt(4)
    buffer_load_dwordx4 v10, s[36:39], s57 offen offset:3072 nt lds
    s_waitcnt lgkmcnt(4)
    v_mfma_f32_16x16x32_bf16 v[36:39], v[68:71], v[100:103], 0
    v_mfma_f32_16x16x32_bf16 v[36:39], v[72:75], v[104:107], v[36:39]
    v_mfma_f32_16x16x32_bf16 v[36:39], v[76:79], v[108:111], v[36:39]
    v_mfma_f32_16x16x32_bf16 v[36:39], v[80:83], v[112:115], v[36:39]
    s_add_u32 s57, s57, 4096
    s_add_u32 m0, s56, 20480
    s_waitcnt vmcnt(4)
    buffer_load_dwordx4 v10, s[36:39], s57 offen offset:0 nt lds
    s_waitcnt vmcnt(4)
    buffer_load_dwordx4 v10, s[36:39], s57 offen offset:1024 nt lds
    s_waitcnt lgkmcnt(0)
    v_mfma_f32_16x16x32_bf16 v[36:39], v[84:87], v[116:119], v[36:39]
    v_mfma_f32_16x16x32_bf16 v[36:39], v[88:91], v[120:123], v[36:39]
    v_mfma_f32_16x16x32_bf16 v[36:39], v[92:95], v[124:127], v[36:39]
    v_mfma_f32_16x16x32_bf16 v[36:39], v[96:99], v[128:131], v[36:39]
    s_waitcnt vmcnt(4)
    buffer_load_dwordx4 v10, s[36:39], s57 offen offset:2048 nt lds
    s_waitcnt vmcnt(4)
    buffer_load_dwordx4 v10, s[36:39], s57 offen offset:3072 nt lds
    s_nop 3
    v_cndmask_b32 v31, v32, v36, s[60:61]
    v_cvt_pk_bf16_f32 v28, v28, v28
    v_and_b32 v28, 0xffff0000, v28
    v_cvt_pk_bf16_f32 v29, v29, v29
    v_and_b32 v29, 0xffff0000, v29
    v_cvt_pk_bf16_f32 v30, v30, v30
    v_and_b32 v30, 0xffff0000, v30
    v_cvt_pk_bf16_f32 v31, v31, v31
    v_and_b32 v31, 0xffff0000, v31
    s_add_u32 s57, s55, 98304
    s_add_u32 m0, s56, 24576
    s_waitcnt vmcnt(4)
    buffer_load_dwordx4 v10, s[36:39], s57 offen offset:0 nt lds
    v_mul_f32 v28, 0x3db8aa3b, v28
    v_mul_f32 v29, 0x3db8aa3b, v29
    v_mul_f32 v30, 0x3db8aa3b, v30
    v_mul_f32 v31, 0x3db8aa3b, v31
    v_max3_f32 v148, v28, v29, v30
    v_max_f32 v148, v148, v31
    s_nop 1
    v_max_f32_dpp v148, v148, v148 row_ror:8 row_mask:0xf bank_mask:0xf
    s_nop 1
    v_max_f32_dpp v148, v148, v148 row_ror:4 row_mask:0xf bank_mask:0xf
    s_nop 1
    v_max_f32_dpp v148, v148, v148 row_ror:2 row_mask:0xf bank_mask:0xf
    s_nop 1
    v_max_f32_dpp v148, v148, v148 row_ror:1 row_mask:0xf bank_mask:0xf
    s_waitcnt vmcnt(4)
    buffer_load_dwordx4 v10, s[36:39], s57 offen offset:1024 nt lds
    v_mov_b32 v149, v148
    s_nop 1
    v_permlane32_swap_b32 v148, v149
    v_max_f32 v148, v148, v149
    v_sub_f32 v28, v28, v148
    v_sub_f32 v29, v29, v148
    v_sub_f32 v30, v30, v148
    v_sub_f32 v31, v31, v148
    v_exp_f32 v28, v28
    v_exp_f32 v29, v29
    v_exp_f32 v30, v30
    v_exp_f32 v31, v31
    v_add_f32 v150, v28, v29
    v_add_f32 v149, v30, v31
    v_add_f32 v150, v150, v149
    v_cvt_pk_bf16_f32 v28, v28, v28
    v_cvt_pk_bf16_f32 v29, v29, v29
    v_cvt_pk_bf16_f32 v30, v30, v30
    v_cvt_pk_bf16_f32 v31, v31, v31
    ds_write_b32 v17, v28 offset:0
    ds_write_b32 v17, v29 offset:128
    ds_write_b32 v17, v30 offset:256
    ds_write_b32 v17, v31 offset:384
    s_waitcnt vmcnt(4)
    buffer_load_dwordx4 v10, s[36:39], s57 offen offset:2048 nt lds
    v_add_f32_dpp v150, v150, v150 row_ror:8 row_mask:0xf bank_mask:0xf
    s_nop 1
    v_add_f32_dpp v150, v150, v150 row_ror:4 row_mask:0xf bank_mask:0xf
    s_nop 1
    v_add_f32_dpp v150, v150, v150 row_ror:2 row_mask:0xf bank_mask:0xf
    s_nop 1
    v_add_f32_dpp v150, v150, v150 row_ror:1 row_mask:0xf bank_mask:0xf
    s_waitcnt vmcnt(4)
    buffer_load_dwordx4 v10, s[36:39], s57 offen offset:3072 nt lds
    v_mov_b32 v149, v150
    s_nop 1
    v_permlane32_swap_b32 v150, v149
    v_add_f32 v150, v150, v149
    v_mov_b32 v152, v148
    v_mov_b32 v153, v150
    v_lshlrev_b32 v151, 3, v19
    s_lshl_b32 s59, s27, 4
    s_add_u32 s59, s59, 140288
    v_add_u32 v151, s59, v151
    s_mov_b32 exec_lo, 0x10001
    s_mov_b32 exec_hi, 0x0
    ds_write_b64 v151, v[152:153]
    s_mov_b64 exec, -1
    ds_read_b128 v[48:51], v16 offset:0
    s_add_u32 s57, s57, 4096
    s_add_u32 m0, s56, 28672
    s_waitcnt vmcnt(7)
    buffer_load_dwordx4 v10, s[36:39], s57 offen offset:0 nt lds
    s_waitcnt lgkmcnt(0)
    v_and_b32 v52, v48, v20
    v_and_b32 v53, v48, v21
    v_and_b32 v54, v48, v22
    v_and_b32 v55, v48, v23
    v_and_b32 v56, v49, v20
    v_and_b32 v57, v49, v21
    v_and_b32 v58, v49, v22
    v_and_b32 v59, v49, v23
    s_waitcnt vmcnt(7)
    buffer_load_dwordx4 v10, s[36:39], s57 offen offset:1024 nt lds
    v_and_b32 v60, v50, v20
    v_and_b32 v61, v50, v21
    v_and_b32 v62, v50, v22
    v_and_b32 v63, v50, v23
    v_and_b32 v64, v51, v20
    v_and_b32 v65, v51, v21
    v_and_b32 v66, v51, v22
    v_and_b32 v67, v51, v23
    s_waitcnt vmcnt(7)
    buffer_load_dwordx4 v10, s[36:39], s57 offen offset:2048 nt lds
    ds_read_b128 v[100:103], v15 offset:0
    ds_read_b128 v[104:107], v15 offset:256
    ds_read_b128 v[108:111], v15 offset:512
    ds_read_b128 v[112:115], v15 offset:768
    ds_read_b128 v[116:119], v15 offset:1024
    ds_read_b128 v[120:123], v15 offset:1280
    ds_read_b128 v[124:127], v15 offset:1536
    ds_read_b128 v[128:131], v15 offset:1792
    s_waitcnt vmcnt(7)
    buffer_load_dwordx4 v10, s[36:39], s57 offen offset:3072 nt lds
    s_waitcnt lgkmcnt(4)
    v_mfma_f32_16x16x32_bf16 v[40:43], v[52:55], v[100:103], v[40:43]
    v_mfma_f32_16x16x32_bf16 v[44:47], v[52:55], v[104:107], v[44:47]
    v_mfma_f32_16x16x32_bf16 v[40:43], v[56:59], v[108:111], v[40:43]
    v_mfma_f32_16x16x32_bf16 v[44:47], v[56:59], v[112:115], v[44:47]
    s_waitcnt lgkmcnt(0)
    v_mfma_f32_16x16x32_bf16 v[40:43], v[60:63], v[116:119], v[40:43]
    v_mfma_f32_16x16x32_bf16 v[44:47], v[60:63], v[120:123], v[44:47]
    v_mfma_f32_16x16x32_bf16 v[40:43], v[64:67], v[124:127], v[40:43]
    v_mfma_f32_16x16x32_bf16 v[44:47], v[64:67], v[128:131], v[44:47]
    ds_read_b128 v[48:51], v16 offset:64
    s_add_u32 s57, s55, 131072
    s_add_u32 m0, s56, 0
    s_waitcnt vmcnt(7)
    buffer_load_dwordx4 v10, s[36:39], s57 offen offset:0 nt lds
    s_waitcnt lgkmcnt(0)
    v_and_b32 v52, v48, v20
    v_and_b32 v53, v48, v21
    v_and_b32 v54, v48, v22
    v_and_b32 v55, v48, v23
    v_and_b32 v56, v49, v20
    v_and_b32 v57, v49, v21
    v_and_b32 v58, v49, v22
    v_and_b32 v59, v49, v23
    s_waitcnt vmcnt(7)
    buffer_load_dwordx4 v10, s[36:39], s57 offen offset:1024 nt lds
    v_and_b32 v60, v50, v20
    v_and_b32 v61, v50, v21
    v_and_b32 v62, v50, v22
    v_and_b32 v63, v50, v23
    v_and_b32 v64, v51, v20
    v_and_b32 v65, v51, v21
    v_and_b32 v66, v51, v22
    v_and_b32 v67, v51, v23
    s_waitcnt vmcnt(7)
    buffer_load_dwordx4 v10, s[36:39], s57 offen offset:2048 nt lds
    ds_read_b128 v[100:103], v15 offset:8192
    ds_read_b128 v[104:107], v15 offset:8448
    ds_read_b128 v[108:111], v15 offset:8704
    ds_read_b128 v[112:115], v15 offset:8960
    ds_read_b128 v[116:119], v15 offset:9216
    ds_read_b128 v[120:123], v15 offset:9472
    ds_read_b128 v[124:127], v15 offset:9728
    ds_read_b128 v[128:131], v15 offset:9984
    s_waitcnt vmcnt(7)
    buffer_load_dwordx4 v10, s[36:39], s57 offen offset:3072 nt lds
    s_waitcnt lgkmcnt(4)
    v_mfma_f32_16x16x32_bf16 v[40:43], v[52:55], v[100:103], v[40:43]
    v_mfma_f32_16x16x32_bf16 v[44:47], v[52:55], v[104:107], v[44:47]
    v_mfma_f32_16x16x32_bf16 v[40:43], v[56:59], v[108:111], v[40:43]
    v_mfma_f32_16x16x32_bf16 v[44:47], v[56:59], v[112:115], v[44:47]
    s_add_u32 s57, s57, 4096
    s_add_u32 m0, s56, 4096
    s_waitcnt vmcnt(7)
    buffer_load_dwordx4 v10, s[36:39], s57 offen offset:0 nt lds
    s_waitcnt vmcnt(7)
    buffer_load_dwordx4 v10, s[36:39], s57 offen offset:1024 nt lds
    s_waitcnt lgkmcnt(0)
    v_mfma_f32_16x16x32_bf16 v[40:43], v[60:63], v[116:119], v[40:43]
    v_mfma_f32_16x16x32_bf16 v[44:47], v[60:63], v[120:123], v[44:47]
    v_mfma_f32_16x16x32_bf16 v[40:43], v[64:67], v[124:127], v[40:43]
    v_mfma_f32_16x16x32_bf16 v[44:47], v[64:67], v[128:131], v[44:47]
    s_waitcnt vmcnt(7)
    buffer_load_dwordx4 v10, s[36:39], s57 offen offset:2048 nt lds
    s_waitcnt vmcnt(7)
    buffer_load_dwordx4 v10, s[36:39], s57 offen offset:3072 nt lds
    ds_read_b128 v[48:51], v16 offset:128
    s_add_u32 s57, s55, 163840
    s_add_u32 m0, s56, 8192
    s_waitcnt vmcnt(7)
    buffer_load_dwordx4 v10, s[36:39], s57 offen offset:0 nt lds
    s_waitcnt lgkmcnt(0)
    v_and_b32 v52, v48, v20
    v_and_b32 v53, v48, v21
    v_and_b32 v54, v48, v22
    v_and_b32 v55, v48, v23
    v_and_b32 v56, v49, v20
    v_and_b32 v57, v49, v21
    v_and_b32 v58, v49, v22
    v_and_b32 v59, v49, v23
    s_waitcnt vmcnt(7)
    buffer_load_dwordx4 v10, s[36:39], s57 offen offset:1024 nt lds
    v_and_b32 v60, v50, v20
    v_and_b32 v61, v50, v21
    v_and_b32 v62, v50, v22
    v_and_b32 v63, v50, v23
    v_and_b32 v64, v51, v20
    v_and_b32 v65, v51, v21
    v_and_b32 v66, v51, v22
    v_and_b32 v67, v51, v23
    s_waitcnt vmcnt(7)
    buffer_load_dwordx4 v10, s[36:39], s57 offen offset:2048 nt lds
    ds_read_b128 v[100:103], v15 offset:16384
    ds_read_b128 v[104:107], v15 offset:16640
    ds_read_b128 v[108:111], v15 offset:16896
    ds_read_b128 v[112:115], v15 offset:17152
    ds_read_b128 v[116:119], v15 offset:17408
    ds_read_b128 v[120:123], v15 offset:17664
    ds_read_b128 v[124:127], v15 offset:17920
    ds_read_b128 v[128:131], v15 offset:18176
    s_waitcnt vmcnt(7)
    buffer_load_dwordx4 v10, s[36:39], s57 offen offset:3072 nt lds
    s_waitcnt lgkmcnt(4)
    v_mfma_f32_16x16x32_bf16 v[40:43], v[52:55], v[100:103], v[40:43]
    v_mfma_f32_16x16x32_bf16 v[44:47], v[52:55], v[104:107], v[44:47]
    v_mfma_f32_16x16x32_bf16 v[40:43], v[56:59], v[108:111], v[40:43]
    v_mfma_f32_16x16x32_bf16 v[44:47], v[56:59], v[112:115], v[44:47]
    s_add_u32 s57, s57, 4096
    s_add_u32 m0, s56, 12288
    s_waitcnt vmcnt(7)
    buffer_load_dwordx4 v10, s[36:39], s57 offen offset:0 nt lds
    s_waitcnt vmcnt(7)
    buffer_load_dwordx4 v10, s[36:39], s57 offen offset:1024 nt lds
    s_waitcnt lgkmcnt(0)
    v_mfma_f32_16x16x32_bf16 v[40:43], v[60:63], v[116:119], v[40:43]
    v_mfma_f32_16x16x32_bf16 v[44:47], v[60:63], v[120:123], v[44:47]
    v_mfma_f32_16x16x32_bf16 v[40:43], v[64:67], v[124:127], v[40:43]
    v_mfma_f32_16x16x32_bf16 v[44:47], v[64:67], v[128:131], v[44:47]
    s_waitcnt vmcnt(7)
    buffer_load_dwordx4 v10, s[36:39], s57 offen offset:2048 nt lds
    s_waitcnt vmcnt(7)
    buffer_load_dwordx4 v10, s[36:39], s57 offen offset:3072 nt lds
    s_cmp_lg_u32 s27, 0
    s_cbranch_scc1 L_prgw_5
    v_mov_b32 v148, 140480
    v_mov_b32 v149, 1
    ds_write_b32 v148, v149
L_prgw_5:
    ds_read_b128 v[48:51], v16 offset:192
    s_add_u32 s57, s55, 196608
    s_add_u32 m0, s56, 16384
    s_waitcnt vmcnt(7)
    buffer_load_dwordx4 v10, s[36:39], s57 offen offset:0 nt lds
    s_waitcnt lgkmcnt(0)
    v_and_b32 v52, v48, v20
    v_and_b32 v53, v48, v21
    v_and_b32 v54, v48, v22
    v_and_b32 v55, v48, v23
    v_and_b32 v56, v49, v20
    v_and_b32 v57, v49, v21
    v_and_b32 v58, v49, v22
    v_and_b32 v59, v49, v23
    s_waitcnt vmcnt(7)
    buffer_load_dwordx4 v10, s[36:39], s57 offen offset:1024 nt lds
    v_and_b32 v60, v50, v20
    v_and_b32 v61, v50, v21
    v_and_b32 v62, v50, v22
    v_and_b32 v63, v50, v23
    v_and_b32 v64, v51, v20
    v_and_b32 v65, v51, v21
    v_and_b32 v66, v51, v22
    v_and_b32 v67, v51, v23
    s_waitcnt vmcnt(7)
    buffer_load_dwordx4 v10, s[36:39], s57 offen offset:2048 nt lds
    ds_read_b128 v[100:103], v15 offset:24576
    ds_read_b128 v[104:107], v15 offset:24832
    ds_read_b128 v[108:111], v15 offset:25088
    ds_read_b128 v[112:115], v15 offset:25344
    ds_read_b128 v[116:119], v15 offset:25600
    ds_read_b128 v[120:123], v15 offset:25856
    ds_read_b128 v[124:127], v15 offset:26112
    ds_read_b128 v[128:131], v15 offset:26368
    s_waitcnt vmcnt(7)
    buffer_load_dwordx4 v10, s[36:39], s57 offen offset:3072 nt lds
    s_waitcnt lgkmcnt(4)
    v_mfma_f32_16x16x32_bf16 v[40:43], v[52:55], v[100:103], v[40:43]
    v_mfma_f32_16x16x32_bf16 v[44:47], v[52:55], v[104:107], v[44:47]
    v_mfma_f32_16x16x32_bf16 v[40:43], v[56:59], v[108:111], v[40:43]
    v_mfma_f32_16x16x32_bf16 v[44:47], v[56:59], v[112:115], v[44:47]
    s_add_u32 s57, s57, 4096
    s_add_u32 m0, s56, 20480
    s_waitcnt vmcnt(7)
    buffer_load_dwordx4 v10, s[36:39], s57 offen offset:0 nt lds
    s_waitcnt vmcnt(7)
    buffer_load_dwordx4 v10, s[36:39], s57 offen offset:1024 nt lds
    s_waitcnt lgkmcnt(0)
    v_mfma_f32_16x16x32_bf16 v[40:43], v[60:63], v[116:119], v[40:43]
    v_mfma_f32_16x16x32_bf16 v[44:47], v[60:63], v[120:123], v[44:47]
    v_mfma_f32_16x16x32_bf16 v[40:43], v[64:67], v[124:127], v[40:43]
    v_mfma_f32_16x16x32_bf16 v[44:47], v[64:67], v[128:131], v[44:47]
    s_waitcnt vmcnt(7)
    buffer_load_dwordx4 v10, s[36:39], s57 offen offset:2048 nt lds
    s_waitcnt vmcnt(7)
    buffer_load_dwordx4 v10, s[36:39], s57 offen offset:3072 nt lds
    v_lshrrev_b32 v148, 5, v1
    v_lshlrev_b32 v148, 10, v148
    v_lshl_add_u32 v148, v18, 5, v148
    v_and_b32 v149, 1, v19
    v_lshl_add_u32 v148, v149, 4, v148
    s_lshl_b32 s59, s27, 11
    s_add_u32 s59, s59, 140544
    v_add_u32 v180, s59, v148
    s_lshl_b32 s59, s27, 10
    s_add_u32 s59, s59, 140544
    v_add_u32 v181, s59, v10
    s_lshl_b32 s59, s27, 4
    s_add_u32 s59, s59, 140416
    v_mov_b32 v182, s59
    s_lshl_b32 s48, s28, 16
    s_lshl_b32 s59, s29, 11
    s_add_u32 s48, s48, s59
    s_lshl_b32 s59, s27, 10
    s_add_u32 s48, s48, s59
    s_add_u32 s48, s48, 163840
    s_lshl_b32 s49, s28, 16
    s_lshl_b32 s59, s29, 6
    s_add_u32 s49, s49, s59
    s_add_u32 s49, s49, 163840
    s_add_u32 s50, s49, 32768
    v_lshlrev_b32 v183, 11, v18
    v_lshl_add_u32 v183, v19, 4, v183
    s_mul_i32 s51, s2, 1792
    s_lshl_b32 s59, s27, 9
    s_add_u32 s51, s51, s59
    s_add_u32 s51, s51, 2293760
    v_lshlrev_b32 v184, 4, v1
    s_mov_b32 s66, -1
    s_mov_b32 s67, 0
    s_cmp_eq_u32 s27, 3
    s_cselect_b32 s66, 0x0000ffff, s66
    ds_read_b128 v[48:51], v16 offset:256
    s_add_u32 s57, s55, 229376
    s_add_u32 m0, s56, 24576
    s_waitcnt vmcnt(7)
    buffer_load_dwordx4 v10, s[36:39], s57 offen offset:0 nt lds
    s_waitcnt lgkmcnt(0)
    v_and_b32 v52, v48, v20
    v_and_b32 v53, v48, v21
    v_and_b32 v54, v48, v22
    v_and_b32 v55, v48, v23
    v_and_b32 v56, v49, v20
    v_and_b32 v57, v49, v21
    v_and_b32 v58, v49, v22
    v_and_b32 v59, v49, v23
    s_waitcnt vmcnt(7)
    buffer_load_dwordx4 v10, s[36:39], s57 offen offset:1024 nt lds
    v_and_b32 v60, v50, v20
    v_and_b32 v61, v50, v21
    v_and_b32 v62, v50, v22
    v_and_b32 v63, v50, v23
    v_and_b32 v64, v51, v20
    v_and_b32 v65, v51, v21
    v_and_b32 v66, v51, v22
    v_and_b32 v67, v51, v23
    s_waitcnt vmcnt(7)
    buffer_load_dwordx4 v10, s[36:39], s57 offen offset:2048 nt lds
    ds_read_b128 v[100:103], v15 offset:0
    ds_read_b128 v[104:107], v15 offset:256
    ds_read_b128 v[108:111], v15 offset:512
    ds_read_b128 v[112:115], v15 offset:768
    ds_read_b128 v[116:119], v15 offset:1024
    ds_read_b128 v[120:123], v15 offset:1280
    ds_read_b128 v[124:127], v15 offset:1536
    ds_read_b128 v[128:131], v15 offset:1792
    s_waitcnt vmcnt(7)
    buffer_load_dwordx4 v10, s[36:39], s57 offen offset:3072 nt lds
    s_waitcnt lgkmcnt(4)
    v_mfma_f32_16x16x32_bf16 v[40:43], v[52:55], v[100:103], v[40:43]
    v_mfma_f32_16x16x32_bf16 v[44:47], v[52:55], v[104:107], v[44:47]
    v_mfma_f32_16x16x32_bf16 v[40:43], v[56:59], v[108:111], v[40:43]
    v_mfma_f32_16x16x32_bf16 v[44:47], v[56:59], v[112:115], v[44:47]
    s_add_u32 s57, s57, 4096
    s_add_u32 m0, s56, 28672
    s_waitcnt vmcnt(7)
    buffer_load_dwordx4 v10, s[36:39], s57 offen offset:0 nt lds
    s_waitcnt vmcnt(7)
    buffer_load_dwordx4 v10, s[36:39], s57 offen offset:1024 nt lds
    s_waitcnt lgkmcnt(0)
    v_mfma_f32_16x16x32_bf16 v[40:43], v[60:63], v[116:119], v[40:43]
    v_mfma_f32_16x16x32_bf16 v[44:47], v[60:63], v[120:123], v[44:47]
    v_mfma_f32_16x16x32_bf16 v[40:43], v[64:67], v[124:127], v[40:43]
    v_mfma_f32_16x16x32_bf16 v[44:47], v[64:67], v[128:131], v[44:47]
    s_waitcnt vmcnt(7)
    buffer_load_dwordx4 v10, s[36:39], s57 offen offset:2048 nt lds
    s_waitcnt vmcnt(7)
    buffer_load_dwordx4 v10, s[36:39], s57 offen offset:3072 nt lds
    s_lshl_b32 s58, s28, 9
    s_lshl_b32 s59, s29, 4
    s_add_u32 s58, s58, s59
    s_mul_i32 s58, s58, 896
    s_lshl_b32 s59, s27, 8
    s_add_u32 s58, s58, s59
    v_mul_u32_u24 v154, 3584, v19
    v_lshl_add_u32 v154, v18, 3, v154
    buffer_load_dwordx2 v[132:133], v154, s[40:43], s58 offen offset:0 nt
    buffer_load_dwordx2 v[134:135], v154, s[40:43], s58 offen offset:128 nt
    buffer_load_dwordx2 v[136:137], v154, s[40:43], s58 offen offset:896 nt
    buffer_load_dwordx2 v[138:139], v154, s[40:43], s58 offen offset:1024 nt
    buffer_load_dwordx2 v[140:141], v154, s[40:43], s58 offen offset:1792 nt
    buffer_load_dwordx2 v[142:143], v154, s[40:43], s58 offen offset:1920 nt
    buffer_load_dwordx2 v[144:145], v154, s[40:43], s58 offen offset:2688 nt
    buffer_load_dwordx2 v[146:147], v154, s[40:43], s58 offen offset:2816 nt
    v_lshrrev_b32 v185, 2, v1
    v_mul_u32_u24 v185, 1792, v185
    v_and_b32 v149, 3, v1
    v_lshl_add_u32 v185, v149, 4, v185
    s_mul_i32 s55, s27, 114688
    s_lshl_b32 s59, s2, 6
    s_add_u32 s55, s55, s59
    s_add_u32 s55, s55, 2293760
    s_add_u32 s56, s55, 28672
    s_add_u32 s57, s55, 57344
    s_add_u32 s58, s55, 86016
    v_and_b32 v148, 1, v19
    v_lshlrev_b32 v148, 1, v148
    v_lshrrev_b32 v150, 1, v19
    v_add_u32 v148, v148, v150
    v_lshl_add_u32 v148, v149, 2, v148
    s_lshl_b32 s59, s27, 6
    s_add_u32 s59, s59, 140544
    v_lshlrev_b32 v148, 2, v148
    v_add_u32 v186, s59, v148
    ds_read_b128 v[48:51], v16 offset:320
    s_waitcnt lgkmcnt(0)
    v_and_b32 v52, v48, v20
    v_and_b32 v53, v48, v21
    v_and_b32 v54, v48, v22
    v_and_b32 v55, v48, v23
    v_and_b32 v56, v49, v20
    v_and_b32 v57, v49, v21
    v_and_b32 v58, v49, v22
    v_and_b32 v59, v49, v23
    v_and_b32 v60, v50, v20
    v_and_b32 v61, v50, v21
    v_and_b32 v62, v50, v22
    v_and_b32 v63, v50, v23
    v_and_b32 v64, v51, v20
    v_and_b32 v65, v51, v21
    v_and_b32 v66, v51, v22
    v_and_b32 v67, v51, v23
    ds_read_b128 v[100:103], v15 offset:8192
    ds_read_b128 v[104:107], v15 offset:8448
    ds_read_b128 v[108:111], v15 offset:8704
    ds_read_b128 v[112:115], v15 offset:8960
    ds_read_b128 v[116:119], v15 offset:9216
    ds_read_b128 v[120:123], v15 offset:9472
    ds_read_b128 v[124:127], v15 offset:9728
    ds_read_b128 v[128:131], v15 offset:9984
    s_waitcnt lgkmcnt(4)
    v_mfma_f32_16x16x32_bf16 v[40:43], v[52:55], v[100:103], v[40:43]
    v_mfma_f32_16x16x32_bf16 v[44:47], v[52:55], v[104:107], v[44:47]
    v_mfma_f32_16x16x32_bf16 v[40:43], v[56:59], v[108:111], v[40:43]
    v_mfma_f32_16x16x32_bf16 v[44:47], v[56:59], v[112:115], v[44:47]
    s_waitcnt lgkmcnt(0)
    v_mfma_f32_16x16x32_bf16 v[40:43], v[60:63], v[116:119], v[40:43]
    v_mfma_f32_16x16x32_bf16 v[44:47], v[60:63], v[120:123], v[44:47]
    v_mfma_f32_16x16x32_bf16 v[40:43], v[64:67], v[124:127], v[40:43]
    v_mfma_f32_16x16x32_bf16 v[44:47], v[64:67], v[128:131], v[44:47]
    ds_read_b128 v[48:51], v16 offset:384
    s_waitcnt lgkmcnt(0)
    v_and_b32 v52, v48, v20
    v_and_b32 v53, v48, v21
    v_and_b32 v54, v48, v22
    v_and_b32 v55, v48, v23
    v_and_b32 v56, v49, v20
    v_and_b32 v57, v49, v21
    v_and_b32 v58, v49, v22
    v_and_b32 v59, v49, v23
    v_and_b32 v60, v50, v20
    v_and_b32 v61, v50, v21
    v_and_b32 v62, v50, v22
    v_and_b32 v63, v50, v23
    v_and_b32 v64, v51, v20
    v_and_b32 v65, v51, v21
    v_and_b32 v66, v51, v22
    v_and_b32 v67, v51, v23
    ds_read_b128 v[100:103], v15 offset:16384
    ds_read_b128 v[104:107], v15 offset:16640
    ds_read_b128 v[108:111], v15 offset:16896
    ds_read_b128 v[112:115], v15 offset:17152
    ds_read_b128 v[116:119], v15 offset:17408
    ds_read_b128 v[120:123], v15 offset:17664
    ds_read_b128 v[124:127], v15 offset:17920
    ds_read_b128 v[128:131], v15 offset:18176
    s_waitcnt lgkmcnt(4)
    v_mfma_f32_16x16x32_bf16 v[40:43], v[52:55], v[100:103], v[40:43]
    v_mfma_f32_16x16x32_bf16 v[44:47], v[52:55], v[104:107], v[44:47]
    v_mfma_f32_16x16x32_bf16 v[40:43], v[56:59], v[108:111], v[40:43]
    v_mfma_f32_16x16x32_bf16 v[44:47], v[56:59], v[112:115], v[44:47]
    s_waitcnt lgkmcnt(0)
    v_mfma_f32_16x16x32_bf16 v[40:43], v[60:63], v[116:119], v[40:43]
    v_mfma_f32_16x16x32_bf16 v[44:47], v[60:63], v[120:123], v[44:47]
    v_mfma_f32_16x16x32_bf16 v[40:43], v[64:67], v[124:127], v[40:43]
    v_mfma_f32_16x16x32_bf16 v[44:47], v[64:67], v[128:131], v[44:47]
    ds_read_b128 v[48:51], v16 offset:448
    s_waitcnt lgkmcnt(0)
    v_and_b32 v52, v48, v20
    v_and_b32 v53, v48, v21
    v_and_b32 v54, v48, v22
    v_and_b32 v55, v48, v23
    v_and_b32 v56, v49, v20
    v_and_b32 v57, v49, v21
    v_and_b32 v58, v49, v22
    v_and_b32 v59, v49, v23
    v_and_b32 v60, v50, v20
    v_and_b32 v61, v50, v21
    v_and_b32 v62, v50, v22
    v_and_b32 v63, v50, v23
    v_and_b32 v64, v51, v20
    v_and_b32 v65, v51, v21
    v_and_b32 v66, v51, v22
    v_and_b32 v67, v51, v23
    s_waitcnt vmcnt(8)
    ds_read_b128 v[100:103], v15 offset:24576
    ds_read_b128 v[104:107], v15 offset:24832
    ds_read_b128 v[108:111], v15 offset:25088
    ds_read_b128 v[112:115], v15 offset:25344
    ds_read_b128 v[116:119], v15 offset:25600
    ds_read_b128 v[120:123], v15 offset:25856
    ds_read_b128 v[124:127], v15 offset:26112
    ds_read_b128 v[128:131], v15 offset:26368
    s_waitcnt lgkmcnt(4)
    v_mfma_f32_16x16x32_bf16 v[40:43], v[52:55], v[100:103], v[40:43]
    v_mfma_f32_16x16x32_bf16 v[44:47], v[52:55], v[104:107], v[44:47]
    v_mfma_f32_16x16x32_bf16 v[40:43], v[56:59], v[108:111], v[40:43]
    v_mfma_f32_16x16x32_bf16 v[44:47], v[56:59], v[112:115], v[44:47]
    s_waitcnt lgkmcnt(0)
    v_mfma_f32_16x16x32_bf16 v[40:43], v[60:63], v[116:119], v[40:43]
    v_mfma_f32_16x16x32_bf16 v[44:47], v[60:63], v[120:123], v[44:47]
    v_mfma_f32_16x16x32_bf16 v[40:43], v[64:67], v[124:127], v[40:43]
    v_mfma_f32_16x16x32_bf16 v[44:47], v[64:67], v[128:131], v[44:47]
    s_nop 6
    ds_write_b128 v180, v[40:43]
    ds_write_b128 v180, v[44:47] offset:512
    s_waitcnt lgkmcnt(0)
    s_barrier
    s_cmp_ge_u32 s27, 2
    s_cbranch_scc1 L_nopub_6
    ds_read_b128 v[100:103], v181 offset:0
    ds_read_b128 v[104:107], v181 offset:2048
    ds_read_b128 v[108:111], v181 offset:4096
    ds_read_b128 v[112:115], v181 offset:6144
    ds_read_b128 v[48:51], v182
    s_waitcnt lgkmcnt(0)
    v_mul_f32 v176, v48, v100
    v_mul_f32 v177, v48, v101
    v_mul_f32 v178, v48, v102
    v_mul_f32 v179, v48, v103
    v_fmac_f32 v176, v49, v104
    v_fmac_f32 v177, v49, v105
    v_fmac_f32 v178, v49, v106
    v_fmac_f32 v179, v49, v107
    v_fmac_f32 v176, v50, v108
    v_fmac_f32 v177, v50, v109
    v_fmac_f32 v178, v50, v110
    v_fmac_f32 v179, v50, v111
    v_fmac_f32 v176, v51, v112
    v_fmac_f32 v177, v51, v113
    v_fmac_f32 v178, v51, v114
    v_fmac_f32 v179, v51, v115
    v_bfi_b32 v176, s52, v24, v176
    v_bfi_b32 v177, s52, v25, v177
    v_bfi_b32 v178, s52, v26, v178
    v_bfi_b32 v179, s52, v27, v179
    buffer_store_dwordx4 v[176:179], v10, s[44:47], s48 offen
L_nopub_6:
    s_mov_b64 s[86:87], -1
    s_mov_b64 s[88:89], -1
    s_mov_b32 s64, 200000
L_pm_7:
    s_mov_b64 exec, s[86:87]
    s_cbranch_execz L_pms_12
    buffer_load_dwordx4 v[100:103], v183, s[44:47], s49 offen sc1
L_pms_12:
    s_mov_b64 exec, s[88:89]
    s_cbranch_execz L_pms_13
    buffer_load_dwordx4 v[104:107], v183, s[44:47], s50 offen sc1
L_pms_13:
    s_waitcnt vmcnt(0)
    s_mov_b64 exec, s[86:87]
    v_xor_b32 v149, v100, v24
    v_bitop3_b32 v149, v101, v25, v149 bitop3:0xbe
    v_bitop3_b32 v149, v102, v26, v149 bitop3:0xbe
    v_bitop3_b32 v149, v103, v27, v149 bitop3:0xbe
    v_lshlrev_b32 v149, 22, v149
    v_cmp_ne_u32 vcc, 0, v149
    s_nop 0
    s_mov_b64 s[86:87], vcc
    s_mov_b64 s[62:63], vcc
    s_mov_b64 exec, s[88:89]
    v_xor_b32 v149, v104, v24
    v_bitop3_b32 v149, v105, v25, v149 bitop3:0xbe
    v_bitop3_b32 v149, v106, v26, v149 bitop3:0xbe
    v_bitop3_b32 v149, v107, v27, v149 bitop3:0xbe
    v_lshlrev_b32 v149, 22, v149
    v_cmp_ne_u32 vcc, 0, v149
    s_nop 0
    s_mov_b64 s[88:89], vcc
    s_or_b64 s[62:63], s[62:63], vcc
    s_mov_b64 exec, -1
    s_cmp_eq_u64 s[62:63], 0
    s_cbranch_scc1 L_pmd_8
    s_sub_u32 s64, s64, 1
    s_cmp_eq_u32 s64, 0
    s_cbranch_scc1 L_pmd_8
    s_cmp_lg_u32 s64, 199960
    s_cbranch_scc1 L_pmn_9
    s_add_u32 s49, s49, 1179648
    s_add_u32 s50, s50, 1179648
L_pmn_9:
    s_branch L_pm_7
L_pmd_8:
    v_add_f32 v100, v100, v104
    v_add_f32 v101, v101, v105
    v_add_f32 v102, v102, v106
    v_add_f32 v103, v103, v107
    v_add_f32_dpp v100, v100, v100 row_ror:8 row_mask:0xf bank_mask:0xf
    v_add_f32_dpp v101, v101, v101 row_ror:8 row_mask:0xf bank_mask:0xf
    v_add_f32_dpp v102, v102, v102 row_ror:8 row_mask:0xf bank_mask:0xf
    v_add_f32_dpp v103, v103, v103 row_ror:8 row_mask:0xf bank_mask:0xf
    v_add_f32_dpp v100, v100, v100 row_ror:4 row_mask:0xf bank_mask:0xf
    v_add_f32_dpp v101, v101, v101 row_ror:4 row_mask:0xf bank_mask:0xf
    v_add_f32_dpp v102, v102, v102 row_ror:4 row_mask:0xf bank_mask:0xf
    v_add_f32_dpp v103, v103, v103 row_ror:4 row_mask:0xf bank_mask:0xf
    v_add_f32_dpp v100, v100, v100 row_ror:2 row_mask:0xf bank_mask:0xf
    v_add_f32_dpp v101, v101, v101 row_ror:2 row_mask:0xf bank_mask:0xf
    v_add_f32_dpp v102, v102, v102 row_ror:2 row_mask:0xf bank_mask:0xf
    v_add_f32_dpp v103, v103, v103 row_ror:2 row_mask:0xf bank_mask:0xf
    v_add_f32_dpp v100, v100, v100 row_ror:1 row_mask:0xf bank_mask:0xf
    v_add_f32_dpp v101, v101, v101 row_ror:1 row_mask:0xf bank_mask:0xf
    v_add_f32_dpp v102, v102, v102 row_ror:1 row_mask:0xf bank_mask:0xf
    v_add_f32_dpp v103, v103, v103 row_ror:1 row_mask:0xf bank_mask:0xf
    v_cvt_pk_bf16_f32 v100, v100, v100
    v_cvt_pk_bf16_f32 v101, v101, v101
    v_cvt_pk_bf16_f32 v102, v102, v102
    v_cvt_pk_bf16_f32 v103, v103, v103
    v_and_b32 v52, v100, v20
    v_and_b32 v53, v100, v21
    v_and_b32 v54, v100, v22
    v_and_b32 v55, v100, v23
    v_and_b32 v56, v101, v20
    v_and_b32 v57, v101, v21
    v_and_b32 v58, v101, v22
    v_and_b32 v59, v101, v23
    v_mfma_f32_16x16x32_bf16 v[32:35], v[52:55], v[132:135], 0
    v_and_b32 v60, v102, v20
    v_and_b32 v61, v102, v21
    v_and_b32 v62, v102, v22
    v_and_b32 v63, v102, v23
    v_mfma_f32_16x16x32_bf16 v[32:35], v[56:59], v[136:139], v[32:35]
    v_and_b32 v64, v103, v20
    v_and_b32 v65, v103, v21
    v_and_b32 v66, v103, v22
    v_and_b32 v67, v103, v23
    v_mfma_f32_16x16x32_bf16 v[32:35], v[60:63], v[140:143], v[32:35]
    s_nop 0
    v_mfma_f32_16x16x32_bf16 v[32:35], v[64:67], v[144:147], v[32:35]
    s_nop 7
    v_bfi_b32 v32, s52, v24, v32
    v_bfi_b32 v33, s52, v25, v33
    v_bfi_b32 v34, s52, v26, v34
    v_bfi_b32 v35, s52, v27, v35
    s_mov_b64 exec, s[66:67]
    buffer_store_dwordx4 v[32:35], v184, s[44:47], s51 offen sc1
    s_mov_b64 exec, -1
    s_cmp_lt_u32 s2, 28
    s_cbranch_scc1 L_scons_14
    s_endpgm
L_scons_14:
L_cons_code:
    s_mov_b64 s[86:87], -1
    s_mov_b64 s[88:89], -1
    s_mov_b64 s[90:91], -1
    s_mov_b64 s[92:93], -1
    s_mov_b32 s64, 200000
L_pm_15:
    s_mov_b64 exec, s[86:87]
    s_cbranch_execz L_pms_20
    buffer_load_dwordx4 v[100:103], v185, s[44:47], s55 offen sc1
L_pms_20:
    s_mov_b64 exec, s[88:89]
    s_cbranch_execz L_pms_21
    buffer_load_dwordx4 v[104:107], v185, s[44:47], s56 offen sc1
L_pms_21:
    s_mov_b64 exec, s[90:91]
    s_cbranch_execz L_pms_22
    buffer_load_dwordx4 v[108:111], v185, s[44:47], s57 offen sc1
L_pms_22:
    s_mov_b64 exec, s[92:93]
    s_cbranch_execz L_pms_23
    buffer_load_dwordx4 v[112:115], v185, s[44:47], s58 offen sc1
L_pms_23:
    s_waitcnt vmcnt(0)
    s_mov_b64 exec, s[86:87]
    v_xor_b32 v149, v100, v24
    v_bitop3_b32 v149, v101, v25, v149 bitop3:0xbe
    v_bitop3_b32 v149, v102, v26, v149 bitop3:0xbe
    v_bitop3_b32 v149, v103, v27, v149 bitop3:0xbe
    v_lshlrev_b32 v149, 22, v149
    v_cmp_ne_u32 vcc, 0, v149
    s_nop 0
    s_mov_b64 s[86:87], vcc
    s_mov_b64 s[62:63], vcc
    s_mov_b64 exec, s[88:89]
    v_xor_b32 v149, v104, v24
    v_bitop3_b32 v149, v105, v25, v149 bitop3:0xbe
    v_bitop3_b32 v149, v106, v26, v149 bitop3:0xbe
    v_bitop3_b32 v149, v107, v27, v149 bitop3:0xbe
    v_lshlrev_b32 v149, 22, v149
    v_cmp_ne_u32 vcc, 0, v149
    s_nop 0
    s_mov_b64 s[88:89], vcc
    s_or_b64 s[62:63], s[62:63], vcc
    s_mov_b64 exec, s[90:91]
    v_xor_b32 v149, v108, v24
    v_bitop3_b32 v149, v109, v25, v149 bitop3:0xbe
    v_bitop3_b32 v149, v110, v26, v149 bitop3:0xbe
    v_bitop3_b32 v149, v111, v27, v149 bitop3:0xbe
    v_lshlrev_b32 v149, 22, v149
    v_cmp_ne_u32 vcc, 0, v149
    s_nop 0
    s_mov_b64 s[90:91], vcc
    s_or_b64 s[62:63], s[62:63], vcc
    s_mov_b64 exec, s[92:93]
    v_xor_b32 v149, v112, v24
    v_bitop3_b32 v149, v113, v25, v149 bitop3:0xbe
    v_bitop3_b32 v149, v114, v26, v149 bitop3:0xbe
    v_bitop3_b32 v149, v115, v27, v149 bitop3:0xbe
    v_lshlrev_b32 v149, 22, v149
    v_cmp_ne_u32 vcc, 0, v149
    s_nop 0
    s_mov_b64 s[92:93], vcc
    s_or_b64 s[62:63], s[62:63], vcc
    s_mov_b64 exec, -1
    s_cmp_eq_u64 s[62:63], 0
    s_cbranch_scc1 L_pmd_16
    s_sub_u32 s64, s64, 1
    s_cmp_eq_u32 s64, 0
    s_cbranch_scc1 L_pmd_16
    s_branch L_pm_15
L_pmd_16:
    v_add_f32 v100, v100, v104
    v_add_f32 v108, v108, v112
    v_add_f32 v101, v101, v105
    v_add_f32 v109, v109, v113
    v_add_f32 v102, v102, v106
    v_add_f32 v110, v110, v114
    v_add_f32 v103, v103, v107
    v_add_f32 v111, v111, v115
    v_add_f32 v100, v100, v108
    v_add_f32 v101, v101, v109
    v_add_f32 v102, v102, v110
    v_add_f32 v103, v103, v111
    v_permlane32_swap_b32 v100, v101
    s_nop 0
    v_permlane32_swap_b32 v102, v103
    v_add_f32 v100, v100, v101
    v_add_f32 v102, v102, v103
    s_nop 1
    v_permlane16_swap_b32 v100, v102
    v_add_f32 v100, v100, v102
    s_nop 1
    v_add_f32_dpp v100, v100, v100 row_ror:4 row_mask:0xf bank_mask:0xf
    s_nop 1
    v_add_f32_dpp v100, v100, v100 row_ror:8 row_mask:0xf bank_mask:0xf
    s_mov_b32 exec_lo, 0xf000f
    s_mov_b32 exec_hi, 0xf000f
    ds_write_b32 v186, v100
    s_waitcnt lgkmcnt(0)
    s_barrier
    s_mov_b64 exec, -1
    s_endpgm
L_cons_code_end:
L_help:
    s_cmp_lg_u32 s27, 4
    s_cbranch_scc1 L_hf
L_hq:
    s_nop 4
    s_setprio 3
    v_and_b32 v2, 15, v1
    v_lshrrev_b32 v3, 4, v1
    v_lshlrev_b32 v4, 4, v1
    v_and_b32 v6, 1, v1
    v_mov_b32 v7, 0xffff
    v_cmp_eq_u32 vcc, 1, v6
    v_mov_b32 v6, 0xffff0000
    s_nop 0
    v_cndmask_b32 v7, v7, v6, vcc
    v_bfe_u32 v6, v1, 1, 2
    v_cmp_eq_u32 vcc, 0, v6
    s_nop 1
    v_cndmask_b32 v28, 0, v7, vcc
    v_cmp_eq_u32 vcc, 1, v6
    s_nop 1
    v_cndmask_b32 v29, 0, v7, vcc
    v_cmp_eq_u32 vcc, 2, v6
    s_nop 1
    v_cndmask_b32 v30, 0, v7, vcc
    v_cmp_eq_u32 vcc, 3, v6
    s_nop 1
    v_cndmask_b32 v31, 0, v7, vcc
    s_waitcnt vmcnt(14)
    v_lshlrev_b32 v12, 16, v204
    v_and_b32 v13, 0xffff0000, v204
    v_lshlrev_b32 v14, 16, v205
    v_and_b32 v15, 0xffff0000, v205
    v_lshlrev_b32 v16, 16, v206
    v_and_b32 v17, 0xffff0000, v206
    v_lshlrev_b32 v18, 16, v207
    v_and_b32 v19, 0xffff0000, v207
    v_readfirstlane_b32 s59, v12
    s_nop 1
    v_subrev_f32 v24, s59, v12
    v_mov_b32 v20, v24
    v_mul_f32 v23, v24, v24
    v_subrev_f32 v24, s59, v13
    v_add_f32 v20, v20, v24
    v_fmac_f32 v23, v24, v24
    v_subrev_f32 v24, s59, v14
    v_add_f32 v20, v20, v24
    v_fmac_f32 v23, v24, v24
    v_subrev_f32 v24, s59, v15
    v_add_f32 v20, v20, v24
    v_fmac_f32 v23, v24, v24
    v_subrev_f32 v24, s59, v16
    v_add_f32 v20, v20, v24
    v_fmac_f32 v23, v24, v24
    v_subrev_f32 v24, s59, v17
    v_add_f32 v20, v20, v24
    v_fmac_f32 v23, v24, v24
    v_subrev_f32 v24, s59, v18
    v_add_f32 v20, v20, v24
    v_fmac_f32 v23, v24, v24
    v_subrev_f32 v24, s59, v19
    v_add_f32 v20, v20, v24
    v_fmac_f32 v23, v24, v24
    v_cmp_gt_u32 vcc, 56, v1
    s_nop 1
    v_cndmask_b32 v20, 0, v20, vcc
    v_cndmask_b32 v23, 0, v23, vcc
    s_nop 0
    v_add_f32_dpp v20, v20, v20 row_ror:8 row_mask:0xf bank_mask:0xf
    v_add_f32_dpp v23, v23, v23 row_ror:8 row_mask:0xf bank_mask:0xf
    s_nop 0
    v_add_f32_dpp v20, v20, v20 row_ror:4 row_mask:0xf bank_mask:0xf
    v_add_f32_dpp v23, v23, v23 row_ror:4 row_mask:0xf bank_mask:0xf
    s_nop 0
    v_add_f32_dpp v20, v20, v20 row_ror:2 row_mask:0xf bank_mask:0xf
    v_add_f32_dpp v23, v23, v23 row_ror:2 row_mask:0xf bank_mask:0xf
    s_nop 0
    v_add_f32_dpp v20, v20, v20 row_ror:1 row_mask:0xf bank_mask:0xf
    v_add_f32_dpp v23, v23, v23 row_ror:1 row_mask:0xf bank_mask:0xf
    v_mov_b32 v21, v20
    v_mov_b32 v27, v23
    s_nop 0
    v_permlane16_swap_b32 v20, v21
    v_permlane16_swap_b32 v23, v27
    v_add_f32 v20, v20, v21
    v_add_f32 v23, v23, v27
    v_mov_b32 v21, v20
    v_mov_b32 v27, v23
    s_nop 0
    v_permlane32_swap_b32 v20, v21
    v_permlane32_swap_b32 v23, v27
    v_add_f32 v20, v20, v21
    v_add_f32 v23, v23, v27
    v_mul_f32 v20, 0x3b124925, v20
    v_mul_f32 v23, 0x3b124925, v23
    v_add_f32 v22, s59, v20
    v_fma_f32 v23, -v20, v20, v23
    v_max_f32 v23, 0, v23
    v_cvt_pk_bf16_f32 v23, v23, v23
    v_and_b32 v23, 0xffff0000, v23
    v_add_f32 v23, 0x3727c5ac, v23
    v_cvt_pk_bf16_f32 v23, v23, v23
    v_and_b32 v23, 0xffff0000, v23
    v_sqrt_f32 v26, v23
    v_cvt_pk_bf16_f32 v22, v22, v22
    v_and_b32 v22, 0xffff0000, v22
    v_cvt_pk_bf16_f32 v26, v26, v26
    v_and_b32 v26, 0xffff0000, v26
    v_rcp_f32 v25, v26
    v_sub_f32 v12, v12, v22
    v_sub_f32 v13, v13, v22
    v_sub_f32 v14, v14, v22
    v_sub_f32 v15, v15, v22
    v_sub_f32 v16, v16, v22
    v_sub_f32 v17, v17, v22
    v_sub_f32 v18, v18, v22
    v_sub_f32 v19, v19, v22
    v_cvt_pk_bf16_f32 v204, v12, v13
    v_cvt_pk_bf16_f32 v205, v14, v15
    v_cvt_pk_bf16_f32 v206, v16, v17
    v_cvt_pk_bf16_f32 v207, v18, v19
    v_lshlrev_b32 v12, 16, v204
    v_and_b32 v13, 0xffff0000, v204
    v_lshlrev_b32 v14, 16, v205
    v_and_b32 v15, 0xffff0000, v205
    v_lshlrev_b32 v16, 16, v206
    v_and_b32 v17, 0xffff0000, v206
    v_lshlrev_b32 v18, 16, v207
    v_and_b32 v19, 0xffff0000, v207
    v_mul_f32 v24, v12, v25
    v_fma_f32 v27, -v24, v26, v12
    v_fmac_f32 v24, v27, v25
    v_cvt_pk_bf16_f32 v12, v24, v24
    v_mul_f32 v24, v13, v25
    v_fma_f32 v27, -v24, v26, v13
    v_fmac_f32 v24, v27, v25
    v_cvt_pk_bf16_f32 v13, v24, v24
    v_mul_f32 v24, v14, v25
    v_fma_f32 v27, -v24, v26, v14
    v_fmac_f32 v24, v27, v25
    v_cvt_pk_bf16_f32 v14, v24, v24
    v_mul_f32 v24, v15, v25
    v_fma_f32 v27, -v24, v26, v15
    v_fmac_f32 v24, v27, v25
    v_cvt_pk_bf16_f32 v15, v24, v24
    v_mul_f32 v24, v16, v25
    v_fma_f32 v27, -v24, v26, v16
    v_fmac_f32 v24, v27, v25
    v_cvt_pk_bf16_f32 v16, v24, v24
    v_mul_f32 v24, v17, v25
    v_fma_f32 v27, -v24, v26, v17
    v_fmac_f32 v24, v27, v25
    v_cvt_pk_bf16_f32 v17, v24, v24
    v_mul_f32 v24, v18, v25
    v_fma_f32 v27, -v24, v26, v18
    v_fmac_f32 v24, v27, v25
    v_cvt_pk_bf16_f32 v18, v24, v24
    v_mul_f32 v24, v19, v25
    v_fma_f32 v27, -v24, v26, v19
    v_fmac_f32 v24, v27, v25
    v_cvt_pk_bf16_f32 v19, v24, v24
    v_lshlrev_b32 v21, 5, v1
    v_add_u32 v21, 132096, v21
    ds_write_b128 v21, v[12:15]
    ds_write_b128 v21, v[16:19] offset:16
    s_waitcnt lgkmcnt(0)
    s_mov_b32 s52, 0x3ff
    s_add_u32 s26, s30, 1
    s_and_b32 s26, s26, 0x3ff
    s_bfe_u32 s53, s30, 0xa000a
    s_add_u32 s53, s53, 1
    s_and_b32 s53, s53, 0x3ff
    v_mov_b32 v32, s26
    v_mov_b32 v33, s53
    s_lshl_b32 s53, s53, 10
    s_or_b32 s30, s26, s53
    s_add_u32 s26, s31, 1
    s_and_b32 s26, s26, 0x3ff
    s_bfe_u32 s53, s31, 0xa000a
    s_add_u32 s53, s53, 1
    s_and_b32 s53, s53, 0x3ff
    v_mov_b32 v34, s26
    v_mov_b32 v35, s53
    s_lshl_b32 s53, s53, 10
    s_or_b32 s31, s26, s53
    v_lshrrev_b32 v48, 3, v2
    v_lshl_add_u32 v48, v3, 1, v48
    s_mul_i32 s58, s65, 112
    v_add_u32 v48, s58, v48
    v_lshlrev_b32 v48, 2, v48
    v_add_u32 v48, 132096, v48
    s_waitcnt lgkmcnt(0)
    ds_read2_b32 v[50:51], v48 offset0:0 offset1:8
    ds_read2_b32 v[52:53], v48 offset0:16 offset1:24
    ds_read2_b32 v[54:55], v48 offset0:32 offset1:40
    ds_read2_b32 v[56:57], v48 offset0:48 offset1:56
    ds_read2_b32 v[58:59], v48 offset0:64 offset1:72
    ds_read2_b32 v[60:61], v48 offset0:80 offset1:88
    ds_read2_b32 v[62:63], v48 offset0:96 offset1:104
    s_waitcnt lgkmcnt(0)
    v_and_b32 v40, v50, v28
    v_and_b32 v41, v50, v29
    v_and_b32 v42, v50, v30
    v_and_b32 v43, v50, v31
    s_waitcnt vmcnt(0)
    v_and_b32 v44, v51, v28
    v_and_b32 v45, v51, v29
    v_and_b32 v46, v51, v30
    v_and_b32 v47, v51, v31
    v_mfma_f32_16x16x32_bf16 v[36:39], v[40:43], v[64:67], 0
    v_and_b32 v40, v52, v28
    v_and_b32 v41, v52, v29
    v_and_b32 v42, v52, v30
    v_and_b32 v43, v52, v31
    v_mfma_f32_16x16x32_bf16 v[36:39], v[44:47], v[68:71], v[36:39]
    v_and_b32 v44, v53, v28
    v_and_b32 v45, v53, v29
    v_and_b32 v46, v53, v30
    v_and_b32 v47, v53, v31
    v_mfma_f32_16x16x32_bf16 v[36:39], v[40:43], v[72:75], v[36:39]
    v_and_b32 v40, v54, v28
    v_and_b32 v41, v54, v29
    v_and_b32 v42, v54, v30
    v_and_b32 v43, v54, v31
    v_mfma_f32_16x16x32_bf16 v[36:39], v[44:47], v[76:79], v[36:39]
    v_and_b32 v44, v55, v28
    v_and_b32 v45, v55, v29
    v_and_b32 v46, v55, v30
    v_and_b32 v47, v55, v31
    v_mfma_f32_16x16x32_bf16 v[36:39], v[40:43], v[80:83], v[36:39]
    v_and_b32 v40, v56, v28
    v_and_b32 v41, v56, v29
    v_and_b32 v42, v56, v30
    v_and_b32 v43, v56, v31
    v_mfma_f32_16x16x32_bf16 v[36:39], v[44:47], v[84:87], v[36:39]
    v_and_b32 v44, v57, v28
    v_and_b32 v45, v57, v29
    v_and_b32 v46, v57, v30
    v_and_b32 v47, v57, v31
    v_mfma_f32_16x16x32_bf16 v[36:39], v[40:43], v[88:91], v[36:39]
    v_and_b32 v40, v58, v28
    v_and_b32 v41, v58, v29
    v_and_b32 v42, v58, v30
    v_and_b32 v43, v58, v31
    v_mfma_f32_16x16x32_bf16 v[36:39], v[44:47], v[92:95], v[36:39]
    v_and_b32 v44, v59, v28
    v_and_b32 v45, v59, v29
    v_and_b32 v46, v59, v30
    v_and_b32 v47, v59, v31
    v_mfma_f32_16x16x32_bf16 v[36:39], v[40:43], v[96:99], v[36:39]
    v_and_b32 v40, v60, v28
    v_and_b32 v41, v60, v29
    v_and_b32 v42, v60, v30
    v_and_b32 v43, v60, v31
    v_mfma_f32_16x16x32_bf16 v[36:39], v[44:47], v[100:103], v[36:39]
    v_and_b32 v44, v61, v28
    v_and_b32 v45, v61, v29
    v_and_b32 v46, v61, v30
    v_and_b32 v47, v61, v31
    v_mfma_f32_16x16x32_bf16 v[36:39], v[40:43], v[104:107], v[36:39]
    v_and_b32 v40, v62, v28
    v_and_b32 v41, v62, v29
    v_and_b32 v42, v62, v30
    v_and_b32 v43, v62, v31
    v_mfma_f32_16x16x32_bf16 v[36:39], v[44:47], v[108:111], v[36:39]
    v_and_b32 v44, v63, v28
    v_and_b32 v45, v63, v29
    v_and_b32 v46, v63, v30
    v_and_b32 v47, v63, v31
    v_mfma_f32_16x16x32_bf16 v[36:39], v[40:43], v[112:115], v[36:39]
    s_nop 0
    v_mfma_f32_16x16x32_bf16 v[36:39], v[44:47], v[116:119], v[36:39]
    s_nop 7
    v_mov_b32 v12, v36
    v_mov_b32 v13, v37
    v_mov_b32 v14, v38
    v_mov_b32 v15, v39
    v_permlane32_swap_b32 v36, v12
    v_permlane32_swap_b32 v37, v13
    v_permlane32_swap_b32 v38, v14
    v_permlane32_swap_b32 v39, v15
    v_add_f32_dpp v36, v12, v36 row_ror:8 row_mask:0xf bank_mask:0xf
    v_add_f32_dpp v37, v13, v37 row_ror:8 row_mask:0xf bank_mask:0xf
    v_add_f32_dpp v38, v14, v38 row_ror:8 row_mask:0xf bank_mask:0xf
    v_add_f32_dpp v39, v15, v39 row_ror:8 row_mask:0xf bank_mask:0xf
    v_bfi_b32 v36, s52, v32, v36
    v_bfi_b32 v37, s52, v33, v37
    v_bfi_b32 v38, s52, v34, v38
    v_bfi_b32 v39, s52, v35, v39
    s_lshl_b32 s57, s28, 2
    s_add_u32 s57, s57, s65
    s_lshl_b32 s57, s57, 11
    s_lshl_b32 s56, s66, 8
    s_add_u32 s57, s57, s56
    s_add_u32 s57, s57, 4096
    v_lshlrev_b32 v5, 5, v2
    v_lshl_add_u32 v5, v3, 4, v5
    s_mov_b32 exec_lo, 0xff00ff
    s_mov_b32 exec_hi, 0x0
    buffer_store_dwordx4 v[36:39], v5, s[44:47], s57 offen
    s_mov_b64 exec, -1
    s_lshl_b32 s55, s28, 13
    s_add_u32 s55, s55, 4096
    s_add_u32 s56, s55, 4096
    s_mov_b64 s[86:87], -1
    s_mov_b64 s[88:89], -1
    s_mov_b64 s[90:91], -1
    s_mov_b64 s[92:93], -1
    s_mov_b64 s[94:95], -1
    s_mov_b64 s[96:97], -1
    s_mov_b64 s[98:99], -1
    s_mov_b64 s[100:101], -1
    s_mov_b32 s64, 200000
L_pm_25:
    s_mov_b64 exec, s[86:87]
    s_cbranch_execz L_pms_29
    buffer_load_dwordx4 v[64:67], v4, s[44:47], s55 offen offset:0 sc1
L_pms_29:
    s_mov_b64 exec, s[88:89]
    s_cbranch_execz L_pms_30
    buffer_load_dwordx4 v[68:71], v4, s[44:47], s55 offen offset:1024 sc1
L_pms_30:
    s_mov_b64 exec, s[90:91]
    s_cbranch_execz L_pms_31
    buffer_load_dwordx4 v[72:75], v4, s[44:47], s55 offen offset:2048 sc1
L_pms_31:
    s_mov_b64 exec, s[92:93]
    s_cbranch_execz L_pms_32
    buffer_load_dwordx4 v[76:79], v4, s[44:47], s55 offen offset:3072 sc1
L_pms_32:
    s_mov_b64 exec, s[94:95]
    s_cbranch_execz L_pms_33
    buffer_load_dwordx4 v[80:83], v4, s[44:47], s56 offen offset:0 sc1
L_pms_33:
    s_mov_b64 exec, s[96:97]
    s_cbranch_execz L_pms_34
    buffer_load_dwordx4 v[84:87], v4, s[44:47], s56 offen offset:1024 sc1
L_pms_34:
    s_mov_b64 exec, s[98:99]
    s_cbranch_execz L_pms_35
    buffer_load_dwordx4 v[88:91], v4, s[44:47], s56 offen offset:2048 sc1
L_pms_35:
    s_mov_b64 exec, s[100:101]
    s_cbranch_execz L_pms_36
    buffer_load_dwordx4 v[92:95], v4, s[44:47], s56 offen offset:3072 sc1
L_pms_36:
    s_waitcnt vmcnt(0)
    s_mov_b64 exec, s[86:87]
    v_xor_b32 v6, v64, v32
    v_bitop3_b32 v6, v65, v33, v6 bitop3:0xbe
    v_bitop3_b32 v6, v66, v34, v6 bitop3:0xbe
    v_bitop3_b32 v6, v67, v35, v6 bitop3:0xbe
    v_lshlrev_b32 v6, 22, v6
    v_cmp_ne_u32 vcc, 0, v6
    s_nop 0
    s_mov_b64 s[86:87], vcc
    s_mov_b64 s[62:63], vcc
    s_mov_b64 exec, s[88:89]
    v_xor_b32 v6, v68, v32
    v_bitop3_b32 v6, v69, v33, v6 bitop3:0xbe
    v_bitop3_b32 v6, v70, v34, v6 bitop3:0xbe
    v_bitop3_b32 v6, v71, v35, v6 bitop3:0xbe
    v_lshlrev_b32 v6, 22, v6
    v_cmp_ne_u32 vcc, 0, v6
    s_nop 0
    s_mov_b64 s[88:89], vcc
    s_or_b64 s[62:63], s[62:63], vcc
    s_mov_b64 exec, s[90:91]
    v_xor_b32 v6, v72, v32
    v_bitop3_b32 v6, v73, v33, v6 bitop3:0xbe
    v_bitop3_b32 v6, v74, v34, v6 bitop3:0xbe
    v_bitop3_b32 v6, v75, v35, v6 bitop3:0xbe
    v_lshlrev_b32 v6, 22, v6
    v_cmp_ne_u32 vcc, 0, v6
    s_nop 0
    s_mov_b64 s[90:91], vcc
    s_or_b64 s[62:63], s[62:63], vcc
    s_mov_b64 exec, s[92:93]
    v_xor_b32 v6, v76, v32
    v_bitop3_b32 v6, v77, v33, v6 bitop3:0xbe
    v_bitop3_b32 v6, v78, v34, v6 bitop3:0xbe
    v_bitop3_b32 v6, v79, v35, v6 bitop3:0xbe
    v_lshlrev_b32 v6, 22, v6
    v_cmp_ne_u32 vcc, 0, v6
    s_nop 0
    s_mov_b64 s[92:93], vcc
    s_or_b64 s[62:63], s[62:63], vcc
    s_mov_b64 exec, s[94:95]
    v_xor_b32 v6, v80, v32
    v_bitop3_b32 v6, v81, v33, v6 bitop3:0xbe
    v_bitop3_b32 v6, v82, v34, v6 bitop3:0xbe
    v_bitop3_b32 v6, v83, v35, v6 bitop3:0xbe
    v_lshlrev_b32 v6, 22, v6
    v_cmp_ne_u32 vcc, 0, v6
    s_nop 0
    s_mov_b64 s[94:95], vcc
    s_or_b64 s[62:63], s[62:63], vcc
    s_mov_b64 exec, s[96:97]
    v_xor_b32 v6, v84, v32
    v_bitop3_b32 v6, v85, v33, v6 bitop3:0xbe
    v_bitop3_b32 v6, v86, v34, v6 bitop3:0xbe
    v_bitop3_b32 v6, v87, v35, v6 bitop3:0xbe
    v_lshlrev_b32 v6, 22, v6
    v_cmp_ne_u32 vcc, 0, v6
    s_nop 0
    s_mov_b64 s[96:97], vcc
    s_or_b64 s[62:63], s[62:63], vcc
    s_mov_b64 exec, s[98:99]
    v_xor_b32 v6, v88, v32
    v_bitop3_b32 v6, v89, v33, v6 bitop3:0xbe
    v_bitop3_b32 v6, v90, v34, v6 bitop3:0xbe
    v_bitop3_b32 v6, v91, v35, v6 bitop3:0xbe
    v_lshlrev_b32 v6, 22, v6
    v_cmp_ne_u32 vcc, 0, v6
    s_nop 0
    s_mov_b64 s[98:99], vcc
    s_or_b64 s[62:63], s[62:63], vcc
    s_mov_b64 exec, s[100:101]
    v_xor_b32 v6, v92, v32
    v_bitop3_b32 v6, v93, v33, v6 bitop3:0xbe
    v_bitop3_b32 v6, v94, v34, v6 bitop3:0xbe
    v_bitop3_b32 v6, v95, v35, v6 bitop3:0xbe
    v_lshlrev_b32 v6, 22, v6
    v_cmp_ne_u32 vcc, 0, v6
    s_nop 0
    s_mov_b64 s[100:101], vcc
    s_or_b64 s[62:63], s[62:63], vcc
    s_mov_b64 exec, -1
    s_cmp_eq_u64 s[62:63], 0
    s_cbranch_scc1 L_pmd_26
    s_sub_u32 s64, s64, 1
    s_cmp_eq_u32 s64, 0
    s_cbranch_scc1 L_pmd_26
    s_cmp_lg_u32 s64, 199997
    s_cbranch_scc1 L_pmb_28
    s_mov_b32 exec_lo, 0xff00ff
    s_mov_b32 exec_hi, 0x0
    s_add_u32 s68, s57, 1179648
    buffer_store_dwordx4 v[36:39], v5, s[44:47], s68 offen sc1
    s_mov_b64 exec, -1
L_pmb_28:
    s_cmp_lg_u32 s64, 199960
    s_cbranch_scc1 L_pmn_27
    s_add_u32 s55, s55, 1179648
    s_add_u32 s56, s56, 1179648
L_pmn_27:
    s_branch L_pm_25
L_pmd_26:
    v_add_f32 v64, v64, v72
    v_add_f32 v120, v80, v88
    v_add_f32 v65, v65, v73
    v_add_f32 v121, v81, v89
    v_add_f32 v66, v66, v74
    v_add_f32 v122, v82, v90
    v_add_f32 v67, v67, v75
    v_add_f32 v123, v83, v91
    v_add_f32 v64, v64, v120
    v_add_f32 v65, v65, v121
    v_add_f32 v66, v66, v122
    v_add_f32 v67, v67, v123
    v_cvt_pk_bf16_f32 v128, v64, v65
    v_cvt_pk_bf16_f32 v129, v66, v67
    v_add_f32 v68, v68, v76
    v_add_f32 v124, v84, v92
    v_add_f32 v69, v69, v77
    v_add_f32 v125, v85, v93
    v_add_f32 v70, v70, v78
    v_add_f32 v126, v86, v94
    v_add_f32 v71, v71, v79
    v_add_f32 v127, v87, v95
    v_add_f32 v68, v68, v124
    v_add_f32 v69, v69, v125
    v_add_f32 v70, v70, v126
    v_add_f32 v71, v71, v127
    v_cvt_pk_bf16_f32 v130, v68, v69
    v_cvt_pk_bf16_f32 v131, v70, v71
    v_lshlrev_b32 v8, 3, v1
    v_add_u32 v8, 131072, v8
    ds_write_b64 v8, v[128:129]
    ds_write_b64 v8, v[130:131] offset:512
    v_mov_b32 v8, 140512
    v_mov_b32 v9, 1
    s_waitcnt lgkmcnt(0)
    ds_write_b32 v8, v9
    s_setprio 0
    s_cmp_le_u32 s64, 199997
    s_cbranch_scc1 L_pme_37
    s_mov_b32 exec_lo, 0xff00ff
    s_mov_b32 exec_hi, 0x0
    s_add_u32 s68, s57, 1179648
    buffer_store_dwordx4 v[36:39], v5, s[44:47], s68 offen sc1
    s_mov_b64 exec, -1
L_pme_37:
    v_and_b32 v5, 7, v1
    v_lshlrev_b32 v5, 3, v5
    v_add_u32 v5, 140288, v5
    s_mov_b32 s64, 1600000
L_mlw_38:
    ds_read_b64 v[8:9], v5
    s_waitcnt lgkmcnt(0)
    v_cmp_neq_f32 vcc, 0, v9
    s_nop 0
    s_cmp_eq_u64 vcc, -1
    s_cbranch_scc1 L_mlwd_39
    s_sub_u32 s64, s64, 1
    s_cmp_eq_u32 s64, 0
    s_cbranch_scc1 L_mlwd_39
    s_sleep 4
    s_branch L_mlw_38
L_mlwd_39:
    v_mov_b32 v10, v8
    s_nop 1
    v_max_f32_dpp v10, v10, v10 quad_perm:[2,3,0,1] row_mask:0xf bank_mask:0xf
    s_nop 1
    v_max_f32_dpp v10, v10, v10 row_ror:4 row_mask:0xf bank_mask:0xf
    v_and_b32 v10, 0xfffffc00, v10
    v_sub_f32 v11, v8, v10
    v_exp_f32 v11, v11
    s_nop 0
    v_mul_f32 v11, v11, v9
    s_nop 1
    v_add_f32_dpp v11, v11, v11 quad_perm:[2,3,0,1] row_mask:0xf bank_mask:0xf
    s_nop 1
    v_add_f32_dpp v11, v11, v11 row_ror:4 row_mask:0xf bank_mask:0xf
    v_mov_b32 v12, v10
    v_mov_b32 v13, v11
    v_mov_b32_dpp v14, v10 quad_perm:[1,0,3,2] row_mask:0xf bank_mask:0xf
    v_mov_b32_dpp v15, v11 quad_perm:[1,0,3,2] row_mask:0xf bank_mask:0xf
    v_bfi_b32 v12, s52, v32, v12
    v_bfi_b32 v13, s52, v33, v13
    v_bfi_b32 v14, s52, v34, v14
    v_bfi_b32 v15, s52, v35, v15
    s_lshl_b32 s55, s28, 12
    s_add_u32 s55, s55, 131072
    s_lshl_b32 s56, s29, 7
    s_add_u32 s56, s56, s55
    v_mov_b32 v7, 0
    s_mov_b64 exec, 1
    buffer_store_dwordx4 v[12:15], v7, s[44:47], s56 offen
    s_mov_b64 exec, -1
    v_and_b32 v6, 31, v1
    v_lshlrev_b32 v6, 7, v6
    s_mov_b64 s[86:87], -1
    s_mov_b32 s64, 200000
L_pm_40:
    s_mov_b64 exec, s[86:87]
    s_cbranch_execz L_pms_45
    buffer_load_dwordx4 v[16:19], v6, s[44:47], s55 offen sc1
L_pms_45:
    s_waitcnt vmcnt(0)
    s_mov_b64 exec, s[86:87]
    v_xor_b32 v20, v16, v32
    v_bitop3_b32 v20, v17, v33, v20 bitop3:0xbe
    v_bitop3_b32 v20, v18, v34, v20 bitop3:0xbe
    v_bitop3_b32 v20, v19, v35, v20 bitop3:0xbe
    v_lshlrev_b32 v20, 22, v20
    v_cmp_ne_u32 vcc, 0, v20
    s_nop 0
    s_mov_b64 s[86:87], vcc
    s_mov_b64 s[62:63], vcc
    s_mov_b64 exec, -1
    s_cmp_eq_u64 s[62:63], 0
    s_cbranch_scc1 L_pmd_41
    s_sub_u32 s64, s64, 1
    s_cmp_eq_u32 s64, 0
    s_cbranch_scc1 L_pmd_41
    s_cmp_lg_u32 s64, 199997
    s_cbranch_scc1 L_pmb_43
    s_mov_b64 exec, 1
    s_add_u32 s68, s56, 1179648
    buffer_store_dwordx4 v[12:15], v7, s[44:47], s68 offen sc1
    s_mov_b64 exec, -1
L_pmb_43:
    s_cmp_lg_u32 s64, 199960
    s_cbranch_scc1 L_pmn_42
    s_add_u32 s55, s55, 1179648
L_pmn_42:
    s_sleep 16
    s_branch L_pm_40
L_pmd_41:
    s_cmp_le_u32 s64, 199997
    s_cbranch_scc1 L_pme_44
    s_mov_b64 exec, 1
    s_add_u32 s68, s56, 1179648
    buffer_store_dwordx4 v[12:15], v7, s[44:47], s68 offen sc1
    s_mov_b64 exec, -1
L_pme_44:
    v_and_b32 v16, 0xfffffc00, v16
    v_and_b32 v17, 0xfffffc00, v17
    v_and_b32 v18, 0xfffffc00, v18
    v_and_b32 v19, 0xfffffc00, v19
    v_mov_b32 v20, v16
    v_mov_b32 v21, v18
    s_nop 0
    v_max_f32_dpp v20, v20, v20 row_ror:8 row_mask:0xf bank_mask:0xf
    v_max_f32_dpp v21, v21, v21 row_ror:8 row_mask:0xf bank_mask:0xf
    s_nop 0
    v_max_f32_dpp v20, v20, v20 row_ror:4 row_mask:0xf bank_mask:0xf
    v_max_f32_dpp v21, v21, v21 row_ror:4 row_mask:0xf bank_mask:0xf
    s_nop 0
    v_max_f32_dpp v20, v20, v20 row_ror:2 row_mask:0xf bank_mask:0xf
    v_max_f32_dpp v21, v21, v21 row_ror:2 row_mask:0xf bank_mask:0xf
    s_nop 0
    v_max_f32_dpp v20, v20, v20 row_ror:1 row_mask:0xf bank_mask:0xf
    v_max_f32_dpp v21, v21, v21 row_ror:1 row_mask:0xf bank_mask:0xf
    v_mov_b32 v22, v20
    v_mov_b32 v23, v21
    s_nop 0
    v_permlane16_swap_b32 v20, v22
    v_permlane16_swap_b32 v21, v23
    v_max_f32 v20, v20, v22
    v_max_f32 v21, v21, v23
    v_sub_f32 v22, v16, v20
    v_sub_f32 v23, v18, v21
    v_exp_f32 v22, v22
    v_exp_f32 v23, v23
    v_mul_f32 v22, v22, v17
    v_mul_f32 v23, v23, v19
    s_nop 0
    v_add_f32_dpp v22, v22, v22 row_ror:8 row_mask:0xf bank_mask:0xf
    v_add_f32_dpp v23, v23, v23 row_ror:8 row_mask:0xf bank_mask:0xf
    s_nop 0
    v_add_f32_dpp v22, v22, v22 row_ror:4 row_mask:0xf bank_mask:0xf
    v_add_f32_dpp v23, v23, v23 row_ror:4 row_mask:0xf bank_mask:0xf
    s_nop 0
    v_add_f32_dpp v22, v22, v22 row_ror:2 row_mask:0xf bank_mask:0xf
    v_add_f32_dpp v23, v23, v23 row_ror:2 row_mask:0xf bank_mask:0xf
    s_nop 0
    v_add_f32_dpp v22, v22, v22 row_ror:1 row_mask:0xf bank_mask:0xf
    v_add_f32_dpp v23, v23, v23 row_ror:1 row_mask:0xf bank_mask:0xf
    v_mov_b32 v24, v22
    v_mov_b32 v25, v23
    s_nop 0
    v_permlane16_swap_b32 v22, v24
    v_permlane16_swap_b32 v23, v25
    v_add_f32 v22, v22, v24
    v_add_f32 v23, v23, v25
    v_and_b32 v6, 1, v1
    v_cmp_eq_u32 vcc, 1, v6
    s_nop 1
    v_cndmask_b32 v20, v20, v21, vcc
    v_cndmask_b32 v22, v22, v23, vcc
    v_sub_f32 v8, v8, v20
    v_exp_f32 v8, v8
    v_rcp_f32 v22, v22
    s_nop 0
    v_mul_f32 v8, v8, v22
    v_lshlrev_b32 v6, 4, v6
    v_bfe_u32 v7, v1, 1, 2
    v_lshl_add_u32 v6, v7, 2, v6
    v_add_u32 v6, 140416, v6
    s_mov_b32 exec_lo, 0xff
    s_mov_b32 exec_hi, 0x0
    ds_write_b32 v6, v8
    s_mov_b64 exec, -1
    v_add_u32 v5, 140544, v4
    v_mov_b32 v6, 140416
    s_lshl_b32 s55, s28, 16
    s_lshl_b32 s56, s29, 11
    s_add_u32 s55, s55, s56
    s_add_u32 s55, s55, 1343488
    s_waitcnt lgkmcnt(0)
    s_barrier
    ds_read_b128 v[64:67], v5 offset:0
    ds_read_b128 v[68:71], v5 offset:2048
    ds_read_b128 v[72:75], v5 offset:4096
    ds_read_b128 v[76:79], v5 offset:6144
    ds_read_b128 v[100:103], v6 offset:0
    ds_read_b128 v[80:83], v5 offset:1024
    ds_read_b128 v[84:87], v5 offset:3072
    ds_read_b128 v[88:91], v5 offset:5120
    ds_read_b128 v[92:95], v5 offset:7168
    ds_read_b128 v[104:107], v6 offset:16
    s_waitcnt lgkmcnt(0)
    v_mul_f32 v108, v100, v64
    v_mul_f32 v109, v100, v65
    v_mul_f32 v110, v100, v66
    v_mul_f32 v111, v100, v67
    v_fmac_f32 v108, v101, v68
    v_fmac_f32 v109, v101, v69
    v_fmac_f32 v110, v101, v70
    v_fmac_f32 v111, v101, v71
    v_fmac_f32 v108, v102, v72
    v_fmac_f32 v109, v102, v73
    v_fmac_f32 v110, v102, v74
    v_fmac_f32 v111, v102, v75
    v_fmac_f32 v108, v103, v76
    v_fmac_f32 v109, v103, v77
    v_fmac_f32 v110, v103, v78
    v_fmac_f32 v111, v103, v79
    v_bfi_b32 v108, s52, v32, v108
    v_bfi_b32 v109, s52, v33, v109
    v_bfi_b32 v110, s52, v34, v110
    v_bfi_b32 v111, s52, v35, v111
    v_mul_f32 v112, v104, v80
    v_mul_f32 v113, v104, v81
    v_mul_f32 v114, v104, v82
    v_mul_f32 v115, v104, v83
    v_fmac_f32 v112, v105, v84
    v_fmac_f32 v113, v105, v85
    v_fmac_f32 v114, v105, v86
    v_fmac_f32 v115, v105, v87
    v_fmac_f32 v112, v106, v88
    v_fmac_f32 v113, v106, v89
    v_fmac_f32 v114, v106, v90
    v_fmac_f32 v115, v106, v91
    v_fmac_f32 v112, v107, v92
    v_fmac_f32 v113, v107, v93
    v_fmac_f32 v114, v107, v94
    v_fmac_f32 v115, v107, v95
    v_bfi_b32 v112, s52, v32, v112
    v_bfi_b32 v113, s52, v33, v113
    v_bfi_b32 v114, s52, v34, v114
    v_bfi_b32 v115, s52, v35, v115
    buffer_store_dwordx4 v[108:111], v4, s[44:47], s55 offen offset:0 sc1
    buffer_store_dwordx4 v[112:115], v4, s[44:47], s55 offen offset:1024 sc1
    s_endpgm
L_hf:
    s_nop 4
    s_waitcnt lgkmcnt(0)
    s_mov_b32 s52, 0x3ff
    s_add_u32 s26, s30, 1
    s_and_b32 s26, s26, 0x3ff
    s_bfe_u32 s53, s30, 0xa000a
    s_add_u32 s53, s53, 1
    s_and_b32 s53, s53, 0x3ff
    v_mov_b32 v32, s26
    v_mov_b32 v33, s53
    s_lshl_b32 s53, s53, 10
    s_or_b32 s30, s26, s53
    s_add_u32 s26, s31, 1
    s_and_b32 s26, s26, 0x3ff
    s_bfe_u32 s53, s31, 0xa000a
    s_add_u32 s53, s53, 1
    s_and_b32 s53, s53, 0x3ff
    v_mov_b32 v34, s26
    v_mov_b32 v35, s53
    s_lshl_b32 s53, s53, 10
    s_or_b32 s31, s26, s53
    s_mov_b32 s32, s4
    s_and_b32 s33, s5, 0xffff
    s_mov_b32 s34, 896
    s_mov_b32 s35, 0x20000
    s_cmp_eq_u32 s28, 5
    s_cselect_b32 s66, 7, s28
    s_cmp_eq_u32 s28, 7
    s_cselect_b32 s66, 5, s66
    s_lshl_b32 s66, s66, 2
    s_lshr_b32 s65, s29, 3
    s_add_u32 s66, s66, s65
    s_cmp_ge_u32 s66, 28
    s_cbranch_scc1 L_hf_noffn
    s_and_b32 s69, s29, 7
    s_lshl_b32 s65, s66, 3
    s_add_u32 s69, s69, s65
    s_and_b32 s65, s29, 4
    s_cmp_lg_u32 s65, 0
    s_cselect_b32 s36, s18, s16
    s_cselect_b32 s37, s19, s17
    s_cselect_b32 s67, 1, 0
    s_and_b32 s37, s37, 0xffff
    s_mov_b32 s38, 1605632
    s_mov_b32 s39, 0x20000
    s_mov_b32 s40, s20
    s_and_b32 s41, s21, 0xffff
    s_mov_b32 s42, 1605632
    s_mov_b32 s43, 0x20000
    s_and_b32 s65, s29, 3
    v_lshlrev_b32 v4, 4, v1
    v_and_b32 v2, 15, v1
    v_lshrrev_b32 v3, 4, v1
    v_lshrrev_b32 v5, 3, v2
    v_lshl_add_u32 v5, v3, 1, v5
    v_mul_u32_u24 v5, 3584, v5
    v_and_b32 v6, 7, v2
    v_lshl_add_u32 v5, v6, 4, v5
    s_mul_i32 s55, s65, 401408
    s_lshl_b32 s56, s66, 7
    s_add_u32 s55, s55, s56
    buffer_load_dwordx4 v[8:11], v4, s[32:35], 0 offen
    buffer_load_dwordx4 v[64:67], v5, s[36:39], s55 offen nt
    s_add_u32 s55, s55, 28672
    buffer_load_dwordx4 v[68:71], v5, s[36:39], s55 offen nt
    s_add_u32 s55, s55, 28672
    buffer_load_dwordx4 v[72:75], v5, s[36:39], s55 offen nt
    s_add_u32 s55, s55, 28672
    buffer_load_dwordx4 v[76:79], v5, s[36:39], s55 offen nt
    s_add_u32 s55, s55, 28672
    buffer_load_dwordx4 v[80:83], v5, s[36:39], s55 offen nt
    s_add_u32 s55, s55, 28672
    buffer_load_dwordx4 v[84:87], v5, s[36:39], s55 offen nt
    s_add_u32 s55, s55, 28672
    buffer_load_dwordx4 v[88:91], v5, s[36:39], s55 offen nt
    s_add_u32 s55, s55, 28672
    s_waitcnt vmcnt(7)
    buffer_load_dwordx4 v[92:95], v5, s[36:39], s55 offen nt
    s_add_u32 s55, s55, 28672
    s_waitcnt vmcnt(7)
    buffer_load_dwordx4 v[96:99], v5, s[36:39], s55 offen nt
    s_add_u32 s55, s55, 28672
    s_waitcnt vmcnt(7)
    buffer_load_dwordx4 v[100:103], v5, s[36:39], s55 offen nt
    s_add_u32 s55, s55, 28672
    s_waitcnt vmcnt(7)
    buffer_load_dwordx4 v[104:107], v5, s[36:39], s55 offen nt
    s_add_u32 s55, s55, 28672
    s_waitcnt vmcnt(7)
    buffer_load_dwordx4 v[108:111], v5, s[36:39], s55 offen nt
    s_add_u32 s55, s55, 28672
    s_waitcnt vmcnt(7)
    buffer_load_dwordx4 v[112:115], v5, s[36:39], s55 offen nt
    s_add_u32 s55, s55, 28672
    s_waitcnt vmcnt(7)
    buffer_load_dwordx4 v[116:119], v5, s[36:39], s55 offen nt
    v_mul_u32_u24 v5, 1792, v3
    v_lshl_add_u32 v5, v2, 4, v5
    s_mul_i32 s55, s69, 7168
    s_add_u32 s56, s55, 896
    s_waitcnt vmcnt(7)
    buffer_load_dwordx4 v[120:123], v5, s[40:43], s55 offen offset:0 nt
    s_waitcnt vmcnt(7)
    buffer_load_dwordx4 v[124:127], v5, s[40:43], s55 offen offset:256 nt
    s_waitcnt vmcnt(7)
    buffer_load_dwordx4 v[128:131], v5, s[40:43], s55 offen offset:512 nt
    s_waitcnt vmcnt(7)
    buffer_load_dwordx4 v[132:135], v5, s[40:43], s55 offen offset:768 nt
    s_waitcnt vmcnt(7)
    buffer_load_dwordx4 v[136:139], v5, s[40:43], s56 offen offset:0 nt
    s_waitcnt vmcnt(7)
    buffer_load_dwordx4 v[140:143], v5, s[40:43], s56 offen offset:256 nt
    s_waitcnt vmcnt(7)
    buffer_load_dwordx4 v[144:147], v5, s[40:43], s56 offen offset:512 nt
    s_waitcnt vmcnt(7)
    buffer_load_dwordx4 v[148:151], v5, s[40:43], s56 offen offset:768 nt
    v_and_b32 v6, 1, v1
    v_mov_b32 v7, 0xffff
    v_cmp_eq_u32 vcc, 1, v6
    v_mov_b32 v6, 0xffff0000
    s_nop 0
    v_cndmask_b32 v7, v7, v6, vcc
    v_bfe_u32 v6, v1, 1, 2
    v_cmp_eq_u32 vcc, 0, v6
    s_nop 1
    v_cndmask_b32 v28, 0, v7, vcc
    v_cmp_eq_u32 vcc, 1, v6
    s_nop 1
    v_cndmask_b32 v29, 0, v7, vcc
    v_cmp_eq_u32 vcc, 2, v6
    s_nop 1
    v_cndmask_b32 v30, 0, v7, vcc
    v_cmp_eq_u32 vcc, 3, v6
    s_nop 1
    v_cndmask_b32 v31, 0, v7, vcc
    s_waitcnt vmcnt(7)
    v_lshlrev_b32 v12, 16, v8
    v_and_b32 v13, 0xffff0000, v8
    v_lshlrev_b32 v14, 16, v9
    v_and_b32 v15, 0xffff0000, v9
    v_lshlrev_b32 v16, 16, v10
    v_and_b32 v17, 0xffff0000, v10
    v_lshlrev_b32 v18, 16, v11
    v_and_b32 v19, 0xffff0000, v11
    v_readfirstlane_b32 s59, v12
    s_nop 1
    v_subrev_f32 v24, s59, v12
    v_mov_b32 v20, v24
    v_mul_f32 v23, v24, v24
    v_subrev_f32 v24, s59, v13
    v_add_f32 v20, v20, v24
    v_fmac_f32 v23, v24, v24
    v_subrev_f32 v24, s59, v14
    v_add_f32 v20, v20, v24
    v_fmac_f32 v23, v24, v24
    v_subrev_f32 v24, s59, v15
    v_add_f32 v20, v20, v24
    v_fmac_f32 v23, v24, v24
    v_subrev_f32 v24, s59, v16
    v_add_f32 v20, v20, v24
    v_fmac_f32 v23, v24, v24
    v_subrev_f32 v24, s59, v17
    v_add_f32 v20, v20, v24
    v_fmac_f32 v23, v24, v24
    v_subrev_f32 v24, s59, v18
    v_add_f32 v20, v20, v24
    v_fmac_f32 v23, v24, v24
    v_subrev_f32 v24, s59, v19
    v_add_f32 v20, v20, v24
    v_fmac_f32 v23, v24, v24
    v_cmp_gt_u32 vcc, 56, v1
    s_nop 1
    v_cndmask_b32 v20, 0, v20, vcc
    v_cndmask_b32 v23, 0, v23, vcc
    s_nop 0
    v_add_f32_dpp v20, v20, v20 row_ror:8 row_mask:0xf bank_mask:0xf
    v_add_f32_dpp v23, v23, v23 row_ror:8 row_mask:0xf bank_mask:0xf
    s_nop 0
    v_add_f32_dpp v20, v20, v20 row_ror:4 row_mask:0xf bank_mask:0xf
    v_add_f32_dpp v23, v23, v23 row_ror:4 row_mask:0xf bank_mask:0xf
    s_nop 0
    v_add_f32_dpp v20, v20, v20 row_ror:2 row_mask:0xf bank_mask:0xf
    v_add_f32_dpp v23, v23, v23 row_ror:2 row_mask:0xf bank_mask:0xf
    s_nop 0
    v_add_f32_dpp v20, v20, v20 row_ror:1 row_mask:0xf bank_mask:0xf
    v_add_f32_dpp v23, v23, v23 row_ror:1 row_mask:0xf bank_mask:0xf
    v_mov_b32 v21, v20
    v_mov_b32 v27, v23
    s_nop 0
    v_permlane16_swap_b32 v20, v21
    v_permlane16_swap_b32 v23, v27
    v_add_f32 v20, v20, v21
    v_add_f32 v23, v23, v27
    v_mov_b32 v21, v20
    v_mov_b32 v27, v23
    s_nop 0
    v_permlane32_swap_b32 v20, v21
    v_permlane32_swap_b32 v23, v27
    v_add_f32 v20, v20, v21
    v_add_f32 v23, v23, v27
    v_mul_f32 v20, 0x3b124925, v20
    v_mul_f32 v23, 0x3b124925, v23
    v_add_f32 v22, s59, v20
    v_fma_f32 v23, -v20, v20, v23
    v_max_f32 v23, 0, v23
    v_cvt_pk_bf16_f32 v23, v23, v23
    v_and_b32 v23, 0xffff0000, v23
    v_add_f32 v23, 0x3727c5ac, v23
    v_cvt_pk_bf16_f32 v23, v23, v23
    v_and_b32 v23, 0xffff0000, v23
    v_sqrt_f32 v26, v23
    v_cvt_pk_bf16_f32 v22, v22, v22
    v_and_b32 v22, 0xffff0000, v22
    v_cvt_pk_bf16_f32 v26, v26, v26
    v_and_b32 v26, 0xffff0000, v26
    v_rcp_f32 v25, v26
    v_sub_f32 v12, v12, v22
    v_sub_f32 v13, v13, v22
    v_sub_f32 v14, v14, v22
    v_sub_f32 v15, v15, v22
    v_sub_f32 v16, v16, v22
    v_sub_f32 v17, v17, v22
    v_sub_f32 v18, v18, v22
    v_sub_f32 v19, v19, v22
    v_cvt_pk_bf16_f32 v8, v12, v13
    v_cvt_pk_bf16_f32 v9, v14, v15
    v_cvt_pk_bf16_f32 v10, v16, v17
    v_cvt_pk_bf16_f32 v11, v18, v19
    v_lshlrev_b32 v12, 16, v8
    v_and_b32 v13, 0xffff0000, v8
    v_lshlrev_b32 v14, 16, v9
    v_and_b32 v15, 0xffff0000, v9
    v_lshlrev_b32 v16, 16, v10
    v_and_b32 v17, 0xffff0000, v10
    v_lshlrev_b32 v18, 16, v11
    v_and_b32 v19, 0xffff0000, v11
    v_mul_f32 v24, v12, v25
    v_fma_f32 v27, -v24, v26, v12
    v_fmac_f32 v24, v27, v25
    v_cvt_pk_bf16_f32 v12, v24, v24
    v_mul_f32 v24, v13, v25
    v_fma_f32 v27, -v24, v26, v13
    v_fmac_f32 v24, v27, v25
    v_cvt_pk_bf16_f32 v13, v24, v24
    v_mul_f32 v24, v14, v25
    v_fma_f32 v27, -v24, v26, v14
    v_fmac_f32 v24, v27, v25
    v_cvt_pk_bf16_f32 v14, v24, v24
    v_mul_f32 v24, v15, v25
    v_fma_f32 v27, -v24, v26, v15
    v_fmac_f32 v24, v27, v25
    v_cvt_pk_bf16_f32 v15, v24, v24
    v_mul_f32 v24, v16, v25
    v_fma_f32 v27, -v24, v26, v16
    v_fmac_f32 v24, v27, v25
    v_cvt_pk_bf16_f32 v16, v24, v24
    v_mul_f32 v24, v17, v25
    v_fma_f32 v27, -v24, v26, v17
    v_fmac_f32 v24, v27, v25
    v_cvt_pk_bf16_f32 v17, v24, v24
    v_mul_f32 v24, v18, v25
    v_fma_f32 v27, -v24, v26, v18
    v_fmac_f32 v24, v27, v25
    v_cvt_pk_bf16_f32 v18, v24, v24
    v_mul_f32 v24, v19, v25
    v_fma_f32 v27, -v24, v26, v19
    v_fmac_f32 v24, v27, v25
    v_cvt_pk_bf16_f32 v19, v24, v24
    v_lshlrev_b32 v21, 5, v1
    v_add_u32 v21, 134144, v21
    ds_write_b128 v21, v[12:15]
    ds_write_b128 v21, v[16:19] offset:16
    v_lshrrev_b32 v48, 3, v2
    v_lshl_add_u32 v48, v3, 1, v48
    s_mul_i32 s58, s65, 112
    v_add_u32 v48, s58, v48
    v_lshlrev_b32 v48, 2, v48
    v_add_u32 v48, 134144, v48
    s_waitcnt lgkmcnt(0)
    ds_read2_b32 v[50:51], v48 offset0:0 offset1:8
    ds_read2_b32 v[52:53], v48 offset0:16 offset1:24
    ds_read2_b32 v[54:55], v48 offset0:32 offset1:40
    ds_read2_b32 v[56:57], v48 offset0:48 offset1:56
    ds_read2_b32 v[58:59], v48 offset0:64 offset1:72
    ds_read2_b32 v[60:61], v48 offset0:80 offset1:88
    ds_read2_b32 v[62:63], v48 offset0:96 offset1:104
    s_waitcnt lgkmcnt(0)
    v_and_b32 v40, v50, v28
    v_and_b32 v41, v50, v29
    v_and_b32 v42, v50, v30
    v_and_b32 v43, v50, v31
    s_waitcnt vmcnt(0)
    v_and_b32 v44, v51, v28
    v_and_b32 v45, v51, v29
    v_and_b32 v46, v51, v30
    v_and_b32 v47, v51, v31
    v_mfma_f32_16x16x32_bf16 v[36:39], v[40:43], v[64:67], 0
    v_and_b32 v40, v52, v28
    v_and_b32 v41, v52, v29
    v_and_b32 v42, v52, v30
    v_and_b32 v43, v52, v31
    v_mfma_f32_16x16x32_bf16 v[36:39], v[44:47], v[68:71], v[36:39]
    v_and_b32 v44, v53, v28
    v_and_b32 v45, v53, v29
    v_and_b32 v46, v53, v30
    v_and_b32 v47, v53, v31
    v_mfma_f32_16x16x32_bf16 v[36:39], v[40:43], v[72:75], v[36:39]
    v_and_b32 v40, v54, v28
    v_and_b32 v41, v54, v29
    v_and_b32 v42, v54, v30
    v_and_b32 v43, v54, v31
    v_mfma_f32_16x16x32_bf16 v[36:39], v[44:47], v[76:79], v[36:39]
    v_and_b32 v44, v55, v28
    v_and_b32 v45, v55, v29
    v_and_b32 v46, v55, v30
    v_and_b32 v47, v55, v31
    v_mfma_f32_16x16x32_bf16 v[36:39], v[40:43], v[80:83], v[36:39]
    v_and_b32 v40, v56, v28
    v_and_b32 v41, v56, v29
    v_and_b32 v42, v56, v30
    v_and_b32 v43, v56, v31
    v_mfma_f32_16x16x32_bf16 v[36:39], v[44:47], v[84:87], v[36:39]
    v_and_b32 v44, v57, v28
    v_and_b32 v45, v57, v29
    v_and_b32 v46, v57, v30
    v_and_b32 v47, v57, v31
    v_mfma_f32_16x16x32_bf16 v[36:39], v[40:43], v[88:91], v[36:39]
    v_and_b32 v40, v58, v28
    v_and_b32 v41, v58, v29
    v_and_b32 v42, v58, v30
    v_and_b32 v43, v58, v31
    v_mfma_f32_16x16x32_bf16 v[36:39], v[44:47], v[92:95], v[36:39]
    v_and_b32 v44, v59, v28
    v_and_b32 v45, v59, v29
    v_and_b32 v46, v59, v30
    v_and_b32 v47, v59, v31
    v_mfma_f32_16x16x32_bf16 v[36:39], v[40:43], v[96:99], v[36:39]
    v_and_b32 v40, v60, v28
    v_and_b32 v41, v60, v29
    v_and_b32 v42, v60, v30
    v_and_b32 v43, v60, v31
    v_mfma_f32_16x16x32_bf16 v[36:39], v[44:47], v[100:103], v[36:39]
    v_and_b32 v44, v61, v28
    v_and_b32 v45, v61, v29
    v_and_b32 v46, v61, v30
    v_and_b32 v47, v61, v31
    v_mfma_f32_16x16x32_bf16 v[36:39], v[40:43], v[104:107], v[36:39]
    v_and_b32 v40, v62, v28
    v_and_b32 v41, v62, v29
    v_and_b32 v42, v62, v30
    v_and_b32 v43, v62, v31
    v_mfma_f32_16x16x32_bf16 v[36:39], v[44:47], v[108:111], v[36:39]
    v_and_b32 v44, v63, v28
    v_and_b32 v45, v63, v29
    v_and_b32 v46, v63, v30
    v_and_b32 v47, v63, v31
    v_mfma_f32_16x16x32_bf16 v[36:39], v[40:43], v[112:115], v[36:39]
    s_nop 0
    v_mfma_f32_16x16x32_bf16 v[36:39], v[44:47], v[116:119], v[36:39]
    s_nop 7
    v_mov_b32 v12, v36
    v_mov_b32 v13, v37
    v_mov_b32 v14, v38
    v_mov_b32 v15, v39
    v_permlane32_swap_b32 v36, v12
    v_permlane32_swap_b32 v37, v13
    v_permlane32_swap_b32 v38, v14
    v_permlane32_swap_b32 v39, v15
    v_add_f32_dpp v36, v12, v36 row_ror:8 row_mask:0xf bank_mask:0xf
    v_add_f32_dpp v37, v13, v37 row_ror:8 row_mask:0xf bank_mask:0xf
    v_add_f32_dpp v38, v14, v38 row_ror:8 row_mask:0xf bank_mask:0xf
    v_add_f32_dpp v39, v15, v39 row_ror:8 row_mask:0xf bank_mask:0xf
    v_bfi_b32 v36, s52, v32, v36
    v_bfi_b32 v37, s52, v33, v37
    v_bfi_b32 v38, s52, v34, v38
    v_bfi_b32 v39, s52, v35, v39
    s_lshl_b32 s57, s67, 2
    s_add_u32 s57, s57, s65
    s_mul_i32 s57, s57, 7168
    s_lshl_b32 s56, s66, 8
    s_add_u32 s57, s57, s56
    s_add_u32 s57, s57, 69632
    v_lshlrev_b32 v7, 5, v2
    v_lshl_add_u32 v7, v3, 4, v7
    s_mov_b32 exec_lo, 0xff00ff
    s_mov_b32 exec_hi, 0x0
    buffer_store_dwordx4 v[36:39], v7, s[44:47], s57 offen
    s_mov_b64 exec, -1
    v_and_b32 v5, 1, v2
    v_lshlrev_b32 v5, 2, v5
    v_lshrrev_b32 v6, 2, v2
    v_add_u32 v5, v5, v6
    v_mul_u32_u24 v5, 7168, v5
    v_lshrrev_b32 v6, 1, v3
    v_lshl_add_u32 v5, v6, 4, v5
    s_lshl_b32 s55, s69, 5
    s_add_u32 s55, s55, 69632
    s_mov_b64 s[86:87], -1
    s_mov_b32 s64, 200000
L_pm_46:
    s_mov_b64 exec, s[86:87]
    s_cbranch_execz L_pms_51
    buffer_load_dwordx4 v[152:155], v5, s[44:47], s55 offen sc1
L_pms_51:
    s_waitcnt vmcnt(0)
    s_mov_b64 exec, s[86:87]
    v_xor_b32 v8, v152, v32
    v_bitop3_b32 v8, v153, v33, v8 bitop3:0xbe
    v_bitop3_b32 v8, v154, v34, v8 bitop3:0xbe
    v_bitop3_b32 v8, v155, v35, v8 bitop3:0xbe
    v_lshlrev_b32 v8, 22, v8
    v_cmp_ne_u32 vcc, 0, v8
    s_nop 0
    s_mov_b64 s[86:87], vcc
    s_mov_b64 s[62:63], vcc
    s_mov_b64 exec, -1
    s_cmp_eq_u64 s[62:63], 0
    s_cbranch_scc1 L_pmd_47
    s_sub_u32 s64, s64, 1
    s_cmp_eq_u32 s64, 0
    s_cbranch_scc1 L_pmd_47
    s_cmp_lg_u32 s64, 199997
    s_cbranch_scc1 L_pmb_49
    s_mov_b32 exec_lo, 0xff00ff
    s_mov_b32 exec_hi, 0x0
    s_add_u32 s68, s57, 1179648
    buffer_store_dwordx4 v[36:39], v7, s[44:47], s68 offen sc1
    s_mov_b64 exec, -1
L_pmb_49:
    s_cmp_lg_u32 s64, 199960
    s_cbranch_scc1 L_pmn_48
    s_add_u32 s55, s55, 1179648
L_pmn_48:
    s_sleep 8
    s_branch L_pm_46
L_pmd_47:
    s_cmp_le_u32 s64, 199997
    s_cbranch_scc1 L_pme_50
    s_mov_b32 exec_lo, 0xff00ff
    s_mov_b32 exec_hi, 0x0
    s_add_u32 s68, s57, 1179648
    buffer_store_dwordx4 v[36:39], v7, s[44:47], s68 offen sc1
    s_mov_b64 exec, -1
L_pme_50:
    s_nop 0
    v_add_f32_dpp v152, v152, v152 row_ror:8 row_mask:0xf bank_mask:0xf
    v_add_f32_dpp v153, v153, v153 row_ror:8 row_mask:0xf bank_mask:0xf
    v_add_f32_dpp v154, v154, v154 row_ror:8 row_mask:0xf bank_mask:0xf
    v_add_f32_dpp v155, v155, v155 row_ror:8 row_mask:0xf bank_mask:0xf
    v_add_f32_dpp v152, v152, v152 row_ror:4 row_mask:0xf bank_mask:0xf
    v_add_f32_dpp v153, v153, v153 row_ror:4 row_mask:0xf bank_mask:0xf
    v_add_f32_dpp v154, v154, v154 row_ror:4 row_mask:0xf bank_mask:0xf
    v_add_f32_dpp v155, v155, v155 row_ror:4 row_mask:0xf bank_mask:0xf
    v_and_b32 v6, 1, v3
    v_cmp_eq_u32 vcc, 1, v6
    s_nop 1
    v_cndmask_b32 v8, v152, v154, vcc
    v_cndmask_b32 v9, v153, v155, vcc
    s_nop 0
    v_mov_b32_dpp v10, v8 quad_perm:[1,0,3,2] row_mask:0xf bank_mask:0xf
    v_mov_b32_dpp v11, v9 quad_perm:[1,0,3,2] row_mask:0xf bank_mask:0xf
    v_and_b32 v6, 1, v2
    v_cmp_eq_u32 vcc, 1, v6
    s_nop 1
    v_cndmask_b32 v12, v8, v10, vcc
    v_cndmask_b32 v13, v9, v11, vcc
    v_cndmask_b32 v14, v10, v8, vcc
    v_cndmask_b32 v15, v11, v9, vcc
    v_cvt_pk_bf16_f32 v12, v12, v12
    v_and_b32 v12, 0xffff0000, v12
    v_cvt_pk_bf16_f32 v14, v14, v14
    v_and_b32 v14, 0xffff0000, v14
    v_cvt_pk_bf16_f32 v13, v13, v13
    v_and_b32 v13, 0xffff0000, v13
    v_cvt_pk_bf16_f32 v15, v15, v15
    v_and_b32 v15, 0xffff0000, v15
    v_mul_f32 v16, v12, v12
    v_mul_f32 v16, v16, v12
    v_mov_b32 v18, 0x3d372713
    v_fma_f32 v16, v16, v18, v12
    v_mul_f32 v16, 0xc0135761, v16
    v_exp_f32 v16, v16
    s_nop 0
    v_add_f32 v16, 1.0, v16
    v_rcp_f32 v16, v16
    s_nop 0
    v_mul_f32 v16, v16, v12
    v_cvt_pk_bf16_f32 v16, v16, v16
    v_and_b32 v16, 0xffff0000, v16
    v_mul_f32 v16, v16, v14
    v_cvt_pk_bf16_f32 v16, v16, v16
    v_mul_f32 v17, v13, v13
    v_mul_f32 v17, v17, v13
    v_mov_b32 v19, 0x3d372713
    v_fma_f32 v17, v17, v19, v13
    v_mul_f32 v17, 0xc0135761, v17
    v_exp_f32 v17, v17
    s_nop 0
    v_add_f32 v17, 1.0, v17
    v_rcp_f32 v17, v17
    s_nop 0
    v_mul_f32 v17, v17, v13
    v_cvt_pk_bf16_f32 v17, v17, v17
    v_and_b32 v17, 0xffff0000, v17
    v_mul_f32 v17, v17, v15
    v_cvt_pk_bf16_f32 v17, v17, v17
    v_and_b32 v40, v16, v28
    v_and_b32 v41, v16, v29
    v_and_b32 v42, v16, v30
    v_and_b32 v43, v16, v31
    v_and_b32 v44, v17, v28
    v_and_b32 v45, v17, v29
    v_and_b32 v46, v17, v30
    v_and_b32 v47, v17, v31
    v_mfma_f32_16x16x32_bf16 v[64:67], v[40:43], v[120:123], 0
    s_nop 0
    v_mfma_f32_16x16x32_bf16 v[64:67], v[44:47], v[136:139], v[64:67]
    v_mfma_f32_16x16x32_bf16 v[68:71], v[40:43], v[124:127], 0
    v_mfma_f32_16x16x32_bf16 v[68:71], v[44:47], v[140:143], v[68:71]
    v_mfma_f32_16x16x32_bf16 v[72:75], v[40:43], v[128:131], 0
    v_mfma_f32_16x16x32_bf16 v[72:75], v[44:47], v[144:147], v[72:75]
    v_mfma_f32_16x16x32_bf16 v[76:79], v[40:43], v[132:135], 0
    v_mfma_f32_16x16x32_bf16 v[76:79], v[44:47], v[148:151], v[76:79]
    s_mul_i32 s55, s69, 1792
    s_add_u32 s55, s55, 1867776
    v_bfi_b32 v64, s52, v32, v64
    v_bfi_b32 v65, s52, v33, v65
    v_bfi_b32 v66, s52, v34, v66
    v_bfi_b32 v67, s52, v35, v67
    v_bfi_b32 v68, s52, v32, v68
    v_bfi_b32 v69, s52, v33, v69
    v_bfi_b32 v70, s52, v34, v70
    v_bfi_b32 v71, s52, v35, v71
    v_bfi_b32 v72, s52, v32, v72
    v_bfi_b32 v73, s52, v33, v73
    v_bfi_b32 v74, s52, v34, v74
    v_bfi_b32 v75, s52, v35, v75
    v_bfi_b32 v76, s52, v32, v76
    v_bfi_b32 v77, s52, v33, v77
    v_bfi_b32 v78, s52, v34, v78
    v_bfi_b32 v79, s52, v35, v79
    s_mov_b32 exec_lo, 0xffffffff
    s_mov_b32 exec_hi, 0x0
    buffer_store_dwordx4 v[64:67], v7, s[44:47], s55 offen offset:0 sc1
    buffer_store_dwordx4 v[68:71], v7, s[44:47], s55 offen offset:512 sc1
    buffer_store_dwordx4 v[72:75], v7, s[44:47], s55 offen offset:1024 sc1
    s_mov_b32 exec_lo, 0xff00ff
    s_mov_b32 exec_hi, 0x0
    buffer_store_dwordx4 v[76:79], v7, s[44:47], s55 offen offset:1536 sc1
    s_mov_b64 exec, -1
L_hf_fin:
    s_cmp_ge_u32 s2, 28
    s_cbranch_scc1 L_hf_nofin_52
    s_getpc_b64 s[56:57]
L_pc_here:
    s_sub_u32 s56, s56, L_pc_here-L_cons_code
    s_subb_u32 s57, s57, 0
    s_load_dword s58, s[56:57], 0
    s_load_dword s58, s[56:57], 64
    s_load_dword s58, s[56:57], 128
    s_load_dword s58, s[56:57], 192
    s_load_dword s58, s[56:57], 256
    s_load_dword s58, s[56:57], 320
    s_load_dword s58, s[56:57], 384
    s_load_dword s58, s[56:57], 448
    s_load_dword s58, s[56:57], 512
    s_load_dword s58, s[56:57], 576
    s_load_dword s58, s[56:57], 640
    s_load_dword s58, s[56:57], 704
    s_load_dword s58, s[56:57], 768
    s_load_dword s58, s[56:57], 832
    s_load_dword s58, s[56:57], 896
    s_load_dword s58, s[56:57], 960
    s_getpc_b64 s[56:57]
L_pc_here2:
    s_add_u32 s56, s56, L_hf_final-L_pc_here2
    s_addc_u32 s57, s57, 0
    s_load_dword s58, s[56:57], 0
    s_load_dword s58, s[56:57], 64
    s_load_dword s58, s[56:57], 128
    s_load_dword s58, s[56:57], 192
    s_load_dword s58, s[56:57], 256
    s_load_dword s58, s[56:57], 320
    s_load_dword s58, s[56:57], 384
    s_load_dword s58, s[56:57], 448
    s_waitcnt lgkmcnt(0)
    v_mov_b32 v8, 140480
    s_mov_b32 s64, 1600000
L_lw_53:
    ds_read_b32 v9, v8
    s_waitcnt lgkmcnt(0)
    v_readfirstlane_b32 s65, v9
    s_nop 0
    s_cmp_eq_u32 s65, 1
    s_cbranch_scc1 L_lwd_54
    s_sub_u32 s64, s64, 1
    s_cmp_eq_u32 s64, 0
    s_cbranch_scc1 L_lwd_54
    s_sleep 8
    s_branch L_lw_53
L_lwd_54:
    v_lshrrev_b32 v5, 2, v1
    v_mul_u32_u24 v5, 1792, v5
    v_and_b32 v6, 3, v1
    v_lshl_add_u32 v5, v6, 4, v5
    s_lshl_b32 s55, s2, 6
    s_add_u32 s55, s55, 1867776
    s_mov_b32 s64, 200000
L_poll_55:
    s_add_u32 s56, s55, 0
    buffer_load_dwordx4 v[64:67], v5, s[44:47], s56 offen sc1
    s_add_u32 s56, s55, 28672
    buffer_load_dwordx4 v[68:71], v5, s[44:47], s56 offen sc1
    s_add_u32 s56, s55, 57344
    buffer_load_dwordx4 v[72:75], v5, s[44:47], s56 offen sc1
    s_add_u32 s56, s55, 86016
    buffer_load_dwordx4 v[76:79], v5, s[44:47], s56 offen sc1
    s_add_u32 s56, s55, 114688
    buffer_load_dwordx4 v[80:83], v5, s[44:47], s56 offen sc1
    s_add_u32 s56, s55, 143360
    buffer_load_dwordx4 v[84:87], v5, s[44:47], s56 offen sc1
    s_add_u32 s56, s55, 172032
    buffer_load_dwordx4 v[88:91], v5, s[44:47], s56 offen sc1
    s_add_u32 s56, s55, 200704
    buffer_load_dwordx4 v[92:95], v5, s[44:47], s56 offen sc1
    s_add_u32 s56, s55, 229376
    buffer_load_dwordx4 v[96:99], v5, s[44:47], s56 offen sc1
    s_add_u32 s56, s55, 258048
    buffer_load_dwordx4 v[100:103], v5, s[44:47], s56 offen sc1
    s_add_u32 s56, s55, 286720
    buffer_load_dwordx4 v[104:107], v5, s[44:47], s56 offen sc1
    s_add_u32 s56, s55, 315392
    buffer_load_dwordx4 v[108:111], v5, s[44:47], s56 offen sc1
    s_add_u32 s56, s55, 344064
    buffer_load_dwordx4 v[112:115], v5, s[44:47], s56 offen sc1
    s_add_u32 s56, s55, 372736
    buffer_load_dwordx4 v[116:119], v5, s[44:47], s56 offen sc1
    s_waitcnt vmcnt(0)
    v_xor_b32 v8, v64, v32
    v_bitop3_b32 v8, v65, v33, v8 bitop3:0xbe
    v_bitop3_b32 v8, v66, v34, v8 bitop3:0xbe
    v_bitop3_b32 v8, v67, v35, v8 bitop3:0xbe
    v_lshlrev_b32 v8, 22, v8
    v_cmp_eq_u32 vcc, 0, v8
    s_nop 0
    s_mov_b64 s[62:63], vcc
    v_xor_b32 v8, v68, v32
    v_bitop3_b32 v8, v69, v33, v8 bitop3:0xbe
    v_bitop3_b32 v8, v70, v34, v8 bitop3:0xbe
    v_bitop3_b32 v8, v71, v35, v8 bitop3:0xbe
    v_lshlrev_b32 v8, 22, v8
    v_cmp_eq_u32 vcc, 0, v8
    s_nop 0
    s_and_b64 s[62:63], s[62:63], vcc
    v_xor_b32 v8, v72, v32
    v_bitop3_b32 v8, v73, v33, v8 bitop3:0xbe
    v_bitop3_b32 v8, v74, v34, v8 bitop3:0xbe
    v_bitop3_b32 v8, v75, v35, v8 bitop3:0xbe
    v_lshlrev_b32 v8, 22, v8
    v_cmp_eq_u32 vcc, 0, v8
    s_nop 0
    s_and_b64 s[62:63], s[62:63], vcc
    v_xor_b32 v8, v76, v32
    v_bitop3_b32 v8, v77, v33, v8 bitop3:0xbe
    v_bitop3_b32 v8, v78, v34, v8 bitop3:0xbe
    v_bitop3_b32 v8, v79, v35, v8 bitop3:0xbe
    v_lshlrev_b32 v8, 22, v8
    v_cmp_eq_u32 vcc, 0, v8
    s_nop 0
    s_and_b64 s[62:63], s[62:63], vcc
    v_xor_b32 v8, v80, v32
    v_bitop3_b32 v8, v81, v33, v8 bitop3:0xbe
    v_bitop3_b32 v8, v82, v34, v8 bitop3:0xbe
    v_bitop3_b32 v8, v83, v35, v8 bitop3:0xbe
    v_lshlrev_b32 v8, 22, v8
    v_cmp_eq_u32 vcc, 0, v8
    s_nop 0
    s_and_b64 s[62:63], s[62:63], vcc
    v_xor_b32 v8, v84, v32
    v_bitop3_b32 v8, v85, v33, v8 bitop3:0xbe
    v_bitop3_b32 v8, v86, v34, v8 bitop3:0xbe
    v_bitop3_b32 v8, v87, v35, v8 bitop3:0xbe
    v_lshlrev_b32 v8, 22, v8
    v_cmp_eq_u32 vcc, 0, v8
    s_nop 0
    s_and_b64 s[62:63], s[62:63], vcc
    v_xor_b32 v8, v88, v32
    v_bitop3_b32 v8, v89, v33, v8 bitop3:0xbe
    v_bitop3_b32 v8, v90, v34, v8 bitop3:0xbe
    v_bitop3_b32 v8, v91, v35, v8 bitop3:0xbe
    v_lshlrev_b32 v8, 22, v8
    v_cmp_eq_u32 vcc, 0, v8
    s_nop 0
    s_and_b64 s[62:63], s[62:63], vcc
    v_xor_b32 v8, v92, v32
    v_bitop3_b32 v8, v93, v33, v8 bitop3:0xbe
    v_bitop3_b32 v8, v94, v34, v8 bitop3:0xbe
    v_bitop3_b32 v8, v95, v35, v8 bitop3:0xbe
    v_lshlrev_b32 v8, 22, v8
    v_cmp_eq_u32 vcc, 0, v8
    s_nop 0
    s_and_b64 s[62:63], s[62:63], vcc
    v_xor_b32 v8, v96, v32
    v_bitop3_b32 v8, v97, v33, v8 bitop3:0xbe
    v_bitop3_b32 v8, v98, v34, v8 bitop3:0xbe
    v_bitop3_b32 v8, v99, v35, v8 bitop3:0xbe
    v_lshlrev_b32 v8, 22, v8
    v_cmp_eq_u32 vcc, 0, v8
    s_nop 0
    s_and_b64 s[62:63], s[62:63], vcc
    v_xor_b32 v8, v100, v32
    v_bitop3_b32 v8, v101, v33, v8 bitop3:0xbe
    v_bitop3_b32 v8, v102, v34, v8 bitop3:0xbe
    v_bitop3_b32 v8, v103, v35, v8 bitop3:0xbe
    v_lshlrev_b32 v8, 22, v8
    v_cmp_eq_u32 vcc, 0, v8
    s_nop 0
    s_and_b64 s[62:63], s[62:63], vcc
    v_xor_b32 v8, v104, v32
    v_bitop3_b32 v8, v105, v33, v8 bitop3:0xbe
    v_bitop3_b32 v8, v106, v34, v8 bitop3:0xbe
    v_bitop3_b32 v8, v107, v35, v8 bitop3:0xbe
    v_lshlrev_b32 v8, 22, v8
    v_cmp_eq_u32 vcc, 0, v8
    s_nop 0
    s_and_b64 s[62:63], s[62:63], vcc
    v_xor_b32 v8, v108, v32
    v_bitop3_b32 v8, v109, v33, v8 bitop3:0xbe
    v_bitop3_b32 v8, v110, v34, v8 bitop3:0xbe
    v_bitop3_b32 v8, v111, v35, v8 bitop3:0xbe
    v_lshlrev_b32 v8, 22, v8
    v_cmp_eq_u32 vcc, 0, v8
    s_nop 0
    s_and_b64 s[62:63], s[62:63], vcc
    v_xor_b32 v8, v112, v32
    v_bitop3_b32 v8, v113, v33, v8 bitop3:0xbe
    v_bitop3_b32 v8, v114, v34, v8 bitop3:0xbe
    v_bitop3_b32 v8, v115, v35, v8 bitop3:0xbe
    v_lshlrev_b32 v8, 22, v8
    v_cmp_eq_u32 vcc, 0, v8
    s_nop 0
    s_and_b64 s[62:63], s[62:63], vcc
    v_xor_b32 v8, v116, v32
    v_bitop3_b32 v8, v117, v33, v8 bitop3:0xbe
    v_bitop3_b32 v8, v118, v34, v8 bitop3:0xbe
    v_bitop3_b32 v8, v119, v35, v8 bitop3:0xbe
    v_lshlrev_b32 v8, 22, v8
    v_cmp_eq_u32 vcc, 0, v8
    s_nop 0
    s_and_b64 s[62:63], s[62:63], vcc
    s_cmp_eq_u64 s[62:63], -1
    s_cbranch_scc1 L_polld_56
    s_sub_u32 s64, s64, 1
    s_cmp_eq_u32 s64, 0
    s_cbranch_scc1 L_polld_56
    s_sleep 32
    s_branch L_poll_55
L_polld_56:
    v_add_f32 v64, v64, v68
    v_add_f32 v65, v65, v69
    v_add_f32 v66, v66, v70
    v_add_f32 v67, v67, v71
    v_add_f32 v64, v64, v72
    v_add_f32 v65, v65, v73
    v_add_f32 v66, v66, v74
    v_add_f32 v67, v67, v75
    v_add_f32 v64, v64, v76
    v_add_f32 v65, v65, v77
    v_add_f32 v66, v66, v78
    v_add_f32 v67, v67, v79
    v_add_f32 v64, v64, v80
    v_add_f32 v65, v65, v81
    v_add_f32 v66, v66, v82
    v_add_f32 v67, v67, v83
    v_add_f32 v64, v64, v84
    v_add_f32 v65, v65, v85
    v_add_f32 v66, v66, v86
    v_add_f32 v67, v67, v87
    v_add_f32 v64, v64, v88
    v_add_f32 v65, v65, v89
    v_add_f32 v66, v66, v90
    v_add_f32 v67, v67, v91
    v_add_f32 v64, v64, v92
    v_add_f32 v65, v65, v93
    v_add_f32 v66, v66, v94
    v_add_f32 v67, v67, v95
    v_add_f32 v64, v64, v96
    v_add_f32 v65, v65, v97
    v_add_f32 v66, v66, v98
    v_add_f32 v67, v67, v99
    v_add_f32 v64, v64, v100
    v_add_f32 v65, v65, v101
    v_add_f32 v66, v66, v102
    v_add_f32 v67, v67, v103
    v_add_f32 v64, v64, v104
    v_add_f32 v65, v65, v105
    v_add_f32 v66, v66, v106
    v_add_f32 v67, v67, v107
    v_add_f32 v64, v64, v108
    v_add_f32 v65, v65, v109
    v_add_f32 v66, v66, v110
    v_add_f32 v67, v67, v111
    v_add_f32 v64, v64, v112
    v_add_f32 v65, v65, v113
    v_add_f32 v66, v66, v114
    v_add_f32 v67, v67, v115
    v_add_f32 v64, v64, v116
    v_add_f32 v65, v65, v117
    v_add_f32 v66, v66, v118
    v_add_f32 v67, v67, v119
    v_permlane32_swap_b32 v64, v65
    s_nop 0
    v_permlane32_swap_b32 v66, v67
    v_add_f32 v64, v64, v65
    v_add_f32 v66, v66, v67
    s_nop 1
    v_permlane16_swap_b32 v64, v66
    v_add_f32 v64, v64, v66
    s_nop 1
    v_add_f32_dpp v64, v64, v64 row_ror:4 row_mask:0xf bank_mask:0xf
    s_nop 1
    v_add_f32_dpp v64, v64, v64 row_ror:8 row_mask:0xf bank_mask:0xf
    v_cvt_pk_bf16_f32 v64, v64, v64
    v_and_b32 v64, 0xffff0000, v64
    v_mul_f32 v10, 0xbfb8aa3b, v64
    v_exp_f32 v10, v10
    s_nop 0
    v_add_f32 v10, 1.0, v10
    v_rcp_f32 v10, v10
    s_nop 0
    v_mul_f32 v10, v10, v64
    v_cvt_pk_bf16_f32 v10, v10, v10
    v_and_b32 v10, 0xffff0000, v10
    v_lshrrev_b32 v12, 4, v1
    v_and_b32 v13, 1, v12
    v_lshlrev_b32 v13, 1, v13
    v_lshrrev_b32 v12, 1, v12
    v_add_u32 v13, v13, v12
    v_and_b32 v11, 3, v1
    v_lshl_add_u32 v11, v11, 2, v13
    s_lshl_b32 s55, s2, 5
    v_lshlrev_b32 v14, 1, v11
    buffer_load_ushort v12, v14, s[32:35], s55 offen
    s_mov_b32 s48, s22
    s_and_b32 s49, s23, 0xffff
    s_mov_b32 s50, 896
    s_mov_b32 s51, 0x20000
    v_lshlrev_b32 v15, 2, v11
    v_add_u32 v15, 140544, v15
    s_waitcnt vmcnt(0)
    v_lshlrev_b32 v12, 16, v12
    s_setprio 3
    s_barrier
    s_barrier
L_hf_final:
    ds_read_b32 v16, v15 offset:0
    ds_read_b32 v17, v15 offset:64
    ds_read_b32 v18, v15 offset:128
    ds_read_b32 v19, v15 offset:192
    s_waitcnt lgkmcnt(0)
    v_add_f32 v16, v16, v17
    v_add_f32 v18, v18, v19
    v_add_f32 v16, v16, v18
    v_cvt_pk_bf16_f32 v16, v16, v16
    v_and_b32 v16, 0xffff0000, v16
    v_mul_f32 v16, v16, v10
    v_cvt_pk_bf16_f32 v16, v16, v16
    v_and_b32 v16, 0xffff0000, v16
    v_add_f32 v16, v16, v12
    v_cvt_pk_bf16_f32 v16, v16, v16
    s_mov_b32 exec_lo, 0xf000f
    s_mov_b32 exec_hi, 0xf000f
    buffer_store_short v16, v14, s[48:51], s55 offen
    s_cmp_lg_u32 s2, 0
    s_cbranch_scc1 L_noep_57
    s_mov_b64 exec, 1
    v_mov_b32 v6, s30
    v_mov_b32 v7, s31
    v_mov_b32 v5, 0
    buffer_store_dwordx2 v[6:7], v5, s[44:47], 0 offen sc1
L_noep_57:
    s_mov_b64 exec, -1
    s_endpgm
L_hf_nofin_52:
    s_endpgm
L_hf_noffn:
    s_cmp_ge_u32 s2, 28
    s_cbranch_scc1 L_end
    s_branch L_hf_fin
L_end:
    s_endpgm
.section .rodata,"a"
.p2align 6
.amdhsa_kernel recurrent_scan__gqa_block_cached__geglu_ffn__decode_kernel
  .amdhsa_next_free_vgpr 256
  .amdhsa_next_free_sgpr 102
  .amdhsa_accum_offset 256
  .amdhsa_group_segment_fixed_size 0
  .amdhsa_kernarg_size 96
  .amdhsa_user_sgpr_count 2
  .amdhsa_user_sgpr_kernarg_segment_ptr 1
  .amdhsa_system_sgpr_workgroup_id_x 1
  .amdhsa_float_denorm_mode_32 3
.end_amdhsa_kernel
```
